```python
import torch

def _softmax(x, axis=-1):
    return torch.softmax(x, dim=axis)
def _gelu(x):
    return torch.nn.functional.gelu(x, approximate="tanh")
def _silu(x):
    return torch.nn.functional.silu(x)
def _sigmoid(x):
    return torch.sigmoid(x)
def _layernorm(x, axis=-1, eps=1e-5):
    m = x.mean(dim=axis, keepdim=True)
    v = x.var(dim=axis, keepdim=True, unbiased=False)
    return (x - m) / torch.sqrt(v + eps)
def _scatter_add(tgt, idx, src, axis=0):
    return tgt.clone().index_add_(axis, idx, src)
def _segment_sum(src, seg, n):
    out = torch.zeros((n,) + src.shape[1:], dtype=src.dtype)
    return out.index_add_(0, seg, src)
def _pad(x, pw):
    flat = tuple(v for pair in reversed(pw) for v in pair)
    return torch.nn.functional.pad(x, flat)

kernel_name = 'sequential_preLN__sliding_block_cached__glu_gated_glu__decode'

def setup_inputs():

    _w = (lambda a: (lambda t: t.to(torch.bfloat16) if t.is_floating_point() else t)(torch.as_tensor(a)))
    def _A_setup():
        B, Sq, D = 2, 1, 512
        Hq, Hkv, Sk, Dh = 32, 8, 32768, 128
        assert Hq % Hkv == 0, (Hq, Hkv)
        return {
            "x": _w((lambda *s: torch.randn(*s, dtype=torch.bfloat16) * 0.05)(B, Sq, D)),
            "k_cache": _w((lambda *s: torch.randn(*s, dtype=torch.bfloat16) * 3.2)(B, Hkv, Sk, Dh)),
            "v_cache": _w((lambda *s: torch.randn(*s, dtype=torch.bfloat16) * 0.4)(B, Hkv, Sk, Dh)),
            "wq": _w((lambda *s: torch.randn(*s, dtype=torch.bfloat16) * 3.2)(D, Hq * Dh) * (D ** -0.5)),
            "wo": _w((lambda *s: torch.randn(*s, dtype=torch.bfloat16) * 0.4)(Hq * Dh, D) * ((Hq * Dh) ** -0.5)),
        }
    _A_in = _A_setup()

    def _B_setup():
        B, S, D, F = 2, 1, 512, 1792
        return {
            "x": _w((lambda *s: torch.randn(*s, dtype=torch.bfloat16) * 0.05)(B, S, D)),
            "w_gate": _w((lambda *s: torch.randn(*s, dtype=torch.bfloat16) * 0.1)(D, F)),
            "w_up": _w((lambda *s: torch.randn(*s, dtype=torch.bfloat16) * 0.05)(D, F)),
            "w_down": _w((lambda *s: torch.randn(*s, dtype=torch.bfloat16) * 0.05)(F, D)),
        }
    _B_in = _B_setup()

    return {
        "A_x": _A_in["x"],
        "A_k_cache": _A_in["k_cache"],
        "A_v_cache": _A_in["v_cache"],
        "A_wq": _A_in["wq"],
        "A_wo": _A_in["wo"],
        "B_x": _B_in["x"],
        "B_w_gate": _B_in["w_gate"],
        "B_w_up": _B_in["w_up"],
        "B_w_down": _B_in["w_down"],
    }

def reference(A_x, A_k_cache, A_v_cache, A_wq, A_wo, B_x, B_w_gate, B_w_up, B_w_down):
    def _A_ref(x, k_cache, v_cache, wq, wo):
        B, Sq, D = x.shape
        Hq, Dh = 32, 128
        Hkv, Sk = k_cache.shape[1], k_cache.shape[2]
        W = min(4096, max(256, Sk // 4))
        rep = Hq // Hkv
        q = (lambda x, *d: x.permute(*d))((x @ wq).reshape(B, Sq, Hq, Dh), 0, 2, 1, 3)
        k = (lambda x, n, axis: torch.repeat_interleave(x, n, dim=axis))(k_cache[:, :, Sk - W:, :], rep, axis=1)
        v = (lambda x, n, axis: torch.repeat_interleave(x, n, dim=axis))(v_cache[:, :, Sk - W:, :], rep, axis=1)
        scores = torch.einsum("bhqd,bhkd->bhqk", q, k) * (Dh ** -0.5)
        p = _softmax(scores, axis=-1)
        o = torch.einsum("bhqk,bhkd->bhqd", p, v)
        return (lambda x, *d: x.permute(*d))(o, 0, 2, 1, 3).reshape(B, Sq, Hq * Dh) @ wo

    def _B_ref(x, w_gate, w_up, w_down):
        g = torch.einsum("bsd,df->bsf", x, w_gate)
        u = torch.einsum("bsd,df->bsf", x, w_up)
        h = _sigmoid(g) * u
        return torch.einsum("bsf,fd->bsd", h, w_down)

    x = A_x
    h = x + _A_ref(_layernorm(x, axis=-1), A_k_cache, A_v_cache, A_wq, A_wo)
    h2 = h + _B_ref(_layernorm(h, axis=-1), B_w_gate, B_w_up, B_w_down)
    return h2
```

```asm
; @launch grid=(256,1,1) block=(256,1,1) lds=65536
.amdgcn_target "amdgcn-amd-amdhsa--gfx950"
.text
.globl sequential_preLN__sliding_block_cached__glu_gated_glu__decode_kernel
.p2align 8
.type sequential_preLN__sliding_block_cached__glu_gated_glu__decode_kernel,@function
sequential_preLN__sliding_block_cached__glu_gated_glu__decode_kernel:
    s_cmp_ge_u32 s2, 256
    s_cbranch_scc1 L_done
    s_load_dwordx16 s[64:79], s[0:1], 0
    s_load_dwordx8 s[84:91], s[0:1], 64
    s_memrealtime s[92:93]
    s_waitcnt lgkmcnt(0)
    s_mov_b32 s8, s64
    s_mov_b32 s9, s65
    s_mov_b32 s10, 2048
    s_mov_b32 s11, 0x00020000
    s_mov_b32 s16, s66
    s_mov_b32 s17, s67
    s_mov_b32 s18, 134217728
    s_mov_b32 s19, 0x00020000
    s_mov_b32 s20, s68
    s_mov_b32 s21, s69
    s_mov_b32 s22, 134217728
    s_mov_b32 s23, 0x00020000
    s_mov_b32 s12, s70
    s_mov_b32 s13, s71
    s_mov_b32 s14, 4194304
    s_mov_b32 s15, 0x00020000
    s_mov_b32 s24, s72
    s_mov_b32 s25, s73
    s_mov_b32 s26, 4194304
    s_mov_b32 s27, 0x00020000
    s_mov_b32 s28, s76
    s_mov_b32 s29, s77
    s_mov_b32 s30, 1835008
    s_mov_b32 s31, 0x00020000
    s_mov_b32 s32, s78
    s_mov_b32 s33, s79
    s_mov_b32 s34, 1835008
    s_mov_b32 s35, 0x00020000
    s_mov_b32 s36, s84
    s_mov_b32 s37, s85
    s_mov_b32 s38, 1835008
    s_mov_b32 s39, 0x00020000
    s_mov_b32 s40, s86
    s_mov_b32 s41, s87
    s_mov_b32 s42, 2048
    s_mov_b32 s43, 0x00020000
    s_mov_b32 s48, s88
    s_mov_b32 s49, s89
    s_mov_b32 s50, 256
    s_mov_b32 s51, 0x00020000
    s_mov_b32 s44, s90
    s_mov_b32 s45, s91
    s_mov_b32 s46, 2097152
    s_mov_b32 s47, 0x00020000
    s_and_b32 s4, s2, 7
    s_lshr_b32 s5, s2, 5
    s_lshl_b32 s5, s5, 3
    s_or_b32 s5, s5, s4
    s_lshl_b32 s5, s5, 2
    s_bfe_u32 s97, s2, 0x20003
    s_add_u32 s97, s97, s5
    s_lshr_b32 s5, s2, 6
    s_lshl_b32 s5, s5, 3
    s_or_b32 s5, s5, s4
    s_lshl_b32 s5, s5, 3
    s_bfe_u32 s6, s2, 0x30003
    s_add_u32 s6, s6, s5
    s_sub_u32 s7, s2, 192
    s_lshr_b32 s7, s7, 3
    s_lshl_b32 s5, s4, 3
    s_add_u32 s7, s7, s5
    s_or_b32 s92, s92, 1
    v_mov_b32 v2, s92
    v_mov_b32 v3, 0
    v_mov_b32 v1, 0
    v_cmp_eq_u32 vcc, 0, v0
    s_and_saveexec_b64 s[82:83], vcc
    buffer_atomic_cmpswap v[2:3], v1, s[48:51], 0 offen sc0
    s_mov_b64 exec, s[82:83]
    v_lshlrev_b32 v1, 3, v0
    buffer_load_dwordx2 v[4:5], v1, s[8:11], 0 offen
    v_lshrrev_b32 v6, 1, v0
    v_lshlrev_b32 v6, 13, v6
    v_and_b32 v7, 1, v0
    v_lshl_add_u32 v6, v7, 4, v6
    s_lshl_b32 s52, s97, 5
    s_add_u32 s53, s52, 0
    buffer_load_dwordx4 v[32:35], v6, s[12:15], s53 offen
    s_add_u32 s53, s52, 1048576
    buffer_load_dwordx4 v[36:39], v6, s[12:15], s53 offen
    s_add_u32 s53, s52, 2097152
    buffer_load_dwordx4 v[40:43], v6, s[12:15], s53 offen
    s_add_u32 s53, s52, 3145728
    buffer_load_dwordx4 v[44:47], v6, s[12:15], s53 offen
    s_lshr_b32 s54, s2, 4
    s_and_b32 s55, s2, 15
    s_lshl_b32 s56, s54, 15
    s_lshl_b32 s57, s55, 8
    s_add_u32 s56, s56, s57
    s_add_u32 s56, s56, 28672
    s_lshl_b32 s56, s56, 8
    v_lshrrev_b32 v8, 6, v0
    v_and_b32 v9, 63, v0
    v_and_b32 v10, 15, v9
    v_lshrrev_b32 v11, 4, v9
    v_lshlrev_b32 v12, 8, v10
    v_lshl_add_u32 v12, v11, 4, v12
    v_lshlrev_b32 v13, 8, v11
    v_lshl_add_u32 v13, v10, 4, v13
    v_lshlrev_b32 v14, 2, v8
    v_add_u32 v14, s2, v14
    v_add_u32 v15, 0, v14
    v_and_b32 v15, 15, v15
    v_lshl_add_u32 v15, v15, 12, v12
    buffer_load_dwordx4 v[48:51], v15, s[16:19], s56 offen offset:0
    buffer_load_dwordx4 v[52:55], v15, s[16:19], s56 offen offset:64
    buffer_load_dwordx4 v[56:59], v15, s[16:19], s56 offen offset:128
    buffer_load_dwordx4 v[60:63], v15, s[16:19], s56 offen offset:192
    v_add_u32 v15, 1, v14
    v_and_b32 v15, 15, v15
    v_lshl_add_u32 v15, v15, 12, v12
    buffer_load_dwordx4 v[64:67], v15, s[16:19], s56 offen offset:0
    buffer_load_dwordx4 v[68:71], v15, s[16:19], s56 offen offset:64
    buffer_load_dwordx4 v[72:75], v15, s[16:19], s56 offen offset:128
    buffer_load_dwordx4 v[76:79], v15, s[16:19], s56 offen offset:192
    v_add_u32 v15, 2, v14
    v_and_b32 v15, 15, v15
    v_lshl_add_u32 v15, v15, 12, v12
    buffer_load_dwordx4 v[80:83], v15, s[16:19], s56 offen offset:0
    buffer_load_dwordx4 v[84:87], v15, s[16:19], s56 offen offset:64
    buffer_load_dwordx4 v[88:91], v15, s[16:19], s56 offen offset:128
    buffer_load_dwordx4 v[92:95], v15, s[16:19], s56 offen offset:192
    v_add_u32 v15, 3, v14
    v_and_b32 v15, 15, v15
    v_lshl_add_u32 v15, v15, 12, v12
    buffer_load_dwordx4 v[96:99], v15, s[16:19], s56 offen offset:0
    buffer_load_dwordx4 v[100:103], v15, s[16:19], s56 offen offset:64
    buffer_load_dwordx4 v[104:107], v15, s[16:19], s56 offen offset:128
    buffer_load_dwordx4 v[108:111], v15, s[16:19], s56 offen offset:192
    s_waitcnt vmcnt(16)
    v_cmp_eq_u32 vcc, 0, v2
    v_mov_b32 v3, s92
    v_cndmask_b32 v2, v2, v3, vcc
    v_mov_b32 v3, 0
    v_cmp_eq_u32 vcc, 0, v0
    s_and_saveexec_b64 s[82:83], vcc
    ds_write_b32 v3, v2 offset:20544
    s_mov_b64 exec, s[82:83]
    v_lshlrev_b32 v16, 16, v4
    v_and_b32 v17, 0xffff0000, v4
    v_lshlrev_b32 v18, 16, v5
    v_and_b32 v19, 0xffff0000, v5
    v_add_f32 v20, v16, v17
    v_add_f32 v21, v18, v19
    v_add_f32 v20, v20, v21
    s_nop 1
    v_add_f32_dpp v20, v20, v20 row_ror:8 row_mask:0xf bank_mask:0xf
    s_nop 1
    v_add_f32_dpp v20, v20, v20 row_ror:4 row_mask:0xf bank_mask:0xf
    s_nop 1
    v_add_f32_dpp v20, v20, v20 row_ror:2 row_mask:0xf bank_mask:0xf
    s_nop 1
    v_add_f32_dpp v20, v20, v20 row_ror:1 row_mask:0xf bank_mask:0xf
    s_nop 1
    v_readlane_b32 s60, v20, 0
    v_readlane_b32 s61, v20, 16
    v_readlane_b32 s62, v20, 32
    v_readlane_b32 s63, v20, 48
    s_nop 1
    v_mov_b32 v20, s60
    v_add_f32 v20, s61, v20
    v_add_f32 v20, s62, v20
    v_add_f32 v20, s63, v20
    v_lshrrev_b32 v21, 6, v0
    v_lshlrev_b32 v21, 2, v21
    ds_write_b32 v21, v20 offset:20480
    s_waitcnt lgkmcnt(0)
    s_barrier
    v_lshrrev_b32 v22, 7, v0
    v_lshlrev_b32 v22, 3, v22
    ds_read_b64 v[24:25], v22 offset:20480
    s_waitcnt lgkmcnt(0)
    v_add_f32 v20, v24, v25
    v_mul_f32 v20, 0x3b000000, v20
    v_sub_f32 v16, v16, v20
    v_sub_f32 v17, v17, v20
    v_sub_f32 v18, v18, v20
    v_sub_f32 v19, v19, v20
    v_mul_f32 v20, v16, v16
    v_fmac_f32 v20, v17, v17
    v_fmac_f32 v20, v18, v18
    v_fmac_f32 v20, v19, v19
    s_nop 1
    v_add_f32_dpp v20, v20, v20 row_ror:8 row_mask:0xf bank_mask:0xf
    s_nop 1
    v_add_f32_dpp v20, v20, v20 row_ror:4 row_mask:0xf bank_mask:0xf
    s_nop 1
    v_add_f32_dpp v20, v20, v20 row_ror:2 row_mask:0xf bank_mask:0xf
    s_nop 1
    v_add_f32_dpp v20, v20, v20 row_ror:1 row_mask:0xf bank_mask:0xf
    s_nop 1
    v_readlane_b32 s60, v20, 0
    v_readlane_b32 s61, v20, 16
    v_readlane_b32 s62, v20, 32
    v_readlane_b32 s63, v20, 48
    s_nop 1
    v_mov_b32 v20, s60
    v_add_f32 v20, s61, v20
    v_add_f32 v20, s62, v20
    v_add_f32 v20, s63, v20
    ds_write_b32 v21, v20 offset:20496
    s_waitcnt lgkmcnt(0)
    s_barrier
    ds_read_b64 v[24:25], v22 offset:20496
    s_waitcnt lgkmcnt(0)
    v_add_f32 v20, v24, v25
    v_mov_b32 v23, 0x3727c5ac
    v_fmac_f32 v23, 0x3b000000, v20
    v_rsq_f32 v23, v23
    s_nop 0
    v_mul_f32 v16, v16, v23
    v_cvt_pk_bf16_f32 v20, v16, v16
    v_lshlrev_b32 v16, 16, v20
    v_mul_f32 v17, v17, v23
    v_cvt_pk_bf16_f32 v20, v17, v17
    v_lshlrev_b32 v17, 16, v20
    v_mul_f32 v18, v18, v23
    v_cvt_pk_bf16_f32 v20, v18, v18
    v_lshlrev_b32 v18, 16, v20
    v_mul_f32 v19, v19, v23
    v_cvt_pk_bf16_f32 v20, v19, v19
    v_lshlrev_b32 v19, 16, v20
    v_mov_b32 v3, 0
    ds_read_b32 v2, v3 offset:20544
    v_lshlrev_b32 v1, 4, v0
    ds_write_b128 v1, v[16:19] offset:16384
    s_waitcnt lgkmcnt(0)
    v_readfirstlane_b32 s80, v2
    s_barrier
    v_mov_b32 v236, 0
    v_mov_b32 v237, 0
    v_mov_b32 v238, 0
    v_mov_b32 v239, 0
    v_mov_b32 v240, 0
    v_mov_b32 v241, 0
    v_mov_b32 v242, 0
    v_mov_b32 v243, 0
    v_mov_b32 v244, 0
    v_mov_b32 v245, 0
    v_mov_b32 v246, 0
    v_mov_b32 v247, 0
    v_mov_b32 v248, 0
    v_mov_b32 v249, 0
    v_mov_b32 v250, 0
    v_mov_b32 v251, 0
    v_lshrrev_b32 v6, 1, v0
    v_lshlrev_b32 v6, 2, v6
    ds_read_b32 v24, v6 offset:16384
    ds_read_b32 v25, v6 offset:18432
    ds_read_b32 v26, v6 offset:16896
    ds_read_b32 v27, v6 offset:18944
    ds_read_b32 v28, v6 offset:17408
    ds_read_b32 v29, v6 offset:19456
    ds_read_b32 v30, v6 offset:17920
    ds_read_b32 v31, v6 offset:19968
    s_waitcnt lgkmcnt(0)
    v_lshlrev_b32 v16, 16, v32
    v_and_b32 v17, 0xffff0000, v32
    v_lshlrev_b32 v18, 16, v33
    v_and_b32 v19, 0xffff0000, v33
    v_lshlrev_b32 v20, 16, v34
    v_and_b32 v21, 0xffff0000, v34
    v_lshlrev_b32 v22, 16, v35
    v_and_b32 v23, 0xffff0000, v35
    v_fmac_f32 v236, v24, v16
    v_fmac_f32 v244, v25, v16
    v_fmac_f32 v237, v24, v17
    v_fmac_f32 v245, v25, v17
    v_fmac_f32 v238, v24, v18
    v_fmac_f32 v246, v25, v18
    v_fmac_f32 v239, v24, v19
    v_fmac_f32 v247, v25, v19
    v_fmac_f32 v240, v24, v20
    v_fmac_f32 v248, v25, v20
    v_fmac_f32 v241, v24, v21
    v_fmac_f32 v249, v25, v21
    v_fmac_f32 v242, v24, v22
    v_fmac_f32 v250, v25, v22
    v_fmac_f32 v243, v24, v23
    v_fmac_f32 v251, v25, v23
    v_lshlrev_b32 v16, 16, v36
    v_and_b32 v17, 0xffff0000, v36
    v_lshlrev_b32 v18, 16, v37
    v_and_b32 v19, 0xffff0000, v37
    v_lshlrev_b32 v20, 16, v38
    v_and_b32 v21, 0xffff0000, v38
    v_lshlrev_b32 v22, 16, v39
    v_and_b32 v23, 0xffff0000, v39
    v_fmac_f32 v236, v26, v16
    v_fmac_f32 v244, v27, v16
    v_fmac_f32 v237, v26, v17
    v_fmac_f32 v245, v27, v17
    v_fmac_f32 v238, v26, v18
    v_fmac_f32 v246, v27, v18
    v_fmac_f32 v239, v26, v19
    v_fmac_f32 v247, v27, v19
    v_fmac_f32 v240, v26, v20
    v_fmac_f32 v248, v27, v20
    v_fmac_f32 v241, v26, v21
    v_fmac_f32 v249, v27, v21
    v_fmac_f32 v242, v26, v22
    v_fmac_f32 v250, v27, v22
    v_fmac_f32 v243, v26, v23
    v_fmac_f32 v251, v27, v23
    v_lshlrev_b32 v16, 16, v40
    v_and_b32 v17, 0xffff0000, v40
    v_lshlrev_b32 v18, 16, v41
    v_and_b32 v19, 0xffff0000, v41
    v_lshlrev_b32 v20, 16, v42
    v_and_b32 v21, 0xffff0000, v42
    v_lshlrev_b32 v22, 16, v43
    v_and_b32 v23, 0xffff0000, v43
    v_fmac_f32 v236, v28, v16
    v_fmac_f32 v244, v29, v16
    v_fmac_f32 v237, v28, v17
    v_fmac_f32 v245, v29, v17
    v_fmac_f32 v238, v28, v18
    v_fmac_f32 v246, v29, v18
    v_fmac_f32 v239, v28, v19
    v_fmac_f32 v247, v29, v19
    v_fmac_f32 v240, v28, v20
    v_fmac_f32 v248, v29, v20
    v_fmac_f32 v241, v28, v21
    v_fmac_f32 v249, v29, v21
    v_fmac_f32 v242, v28, v22
    v_fmac_f32 v250, v29, v22
    v_fmac_f32 v243, v28, v23
    v_fmac_f32 v251, v29, v23
    v_lshlrev_b32 v16, 16, v44
    v_and_b32 v17, 0xffff0000, v44
    v_lshlrev_b32 v18, 16, v45
    v_and_b32 v19, 0xffff0000, v45
    v_lshlrev_b32 v20, 16, v46
    v_and_b32 v21, 0xffff0000, v46
    v_lshlrev_b32 v22, 16, v47
    v_and_b32 v23, 0xffff0000, v47
    v_fmac_f32 v236, v30, v16
    v_fmac_f32 v244, v31, v16
    v_fmac_f32 v237, v30, v17
    v_fmac_f32 v245, v31, v17
    v_fmac_f32 v238, v30, v18
    v_fmac_f32 v246, v31, v18
    v_fmac_f32 v239, v30, v19
    v_fmac_f32 v247, v31, v19
    v_fmac_f32 v240, v30, v20
    v_fmac_f32 v248, v31, v20
    v_fmac_f32 v241, v30, v21
    v_fmac_f32 v249, v31, v21
    v_fmac_f32 v242, v30, v22
    v_fmac_f32 v250, v31, v22
    v_fmac_f32 v243, v30, v23
    v_fmac_f32 v251, v31, v23
    v_lshlrev_b32 v1, 6, v0
    ds_write_b128 v1, v[236:239] offset:0
    ds_write_b128 v1, v[240:243] offset:16
    ds_write_b128 v1, v[244:247] offset:32
    ds_write_b128 v1, v[248:251] offset:48
    s_waitcnt lgkmcnt(0)
    s_barrier
    v_and_b32 v1, 15, v0
    v_lshrrev_b32 v2, 3, v1
    v_lshlrev_b32 v2, 6, v2
    v_and_b32 v3, 7, v1
    v_bfe_u32 v4, v0, 4, 1
    v_lshl_add_u32 v3, v4, 3, v3
    v_lshl_add_u32 v2, v3, 2, v2
    v_lshrrev_b32 v5, 5, v0
    v_lshl_add_u32 v2, v5, 11, v2
    ds_read_b32 v16, v2 offset:0
    ds_read_b32 v17, v2 offset:128
    ds_read_b32 v18, v2 offset:256
    ds_read_b32 v19, v2 offset:384
    ds_read_b32 v20, v2 offset:512
    ds_read_b32 v21, v2 offset:640
    ds_read_b32 v22, v2 offset:768
    ds_read_b32 v23, v2 offset:896
    ds_read_b32 v24, v2 offset:1024
    ds_read_b32 v25, v2 offset:1152
    ds_read_b32 v26, v2 offset:1280
    ds_read_b32 v27, v2 offset:1408
    ds_read_b32 v28, v2 offset:1536
    ds_read_b32 v29, v2 offset:1664
    ds_read_b32 v30, v2 offset:1792
    ds_read_b32 v31, v2 offset:1920
    s_waitcnt lgkmcnt(0)
    v_add_f32 v16, v16, v17
    v_add_f32 v16, v16, v18
    v_add_f32 v16, v16, v19
    v_add_f32 v16, v16, v20
    v_add_f32 v16, v16, v21
    v_add_f32 v16, v16, v22
    v_add_f32 v16, v16, v23
    v_add_f32 v16, v16, v24
    v_add_f32 v16, v16, v25
    v_add_f32 v16, v16, v26
    v_add_f32 v16, v16, v27
    v_add_f32 v16, v16, v28
    v_add_f32 v16, v16, v29
    v_add_f32 v16, v16, v30
    v_add_f32 v16, v16, v31
    v_lshlrev_b32 v1, 2, v0
    ds_write_b32 v1, v16 offset:20736
    s_waitcnt lgkmcnt(0)
    s_barrier
    v_cmp_gt_u32 vcc, 16, v0
    s_and_saveexec_b64 s[82:83], vcc
    v_lshlrev_b32 v1, 3, v0
    ds_read_b64 v[16:17], v1 offset:20736
    ds_read_b64 v[18:19], v1 offset:20864
    ds_read_b64 v[20:21], v1 offset:20992
    ds_read_b64 v[22:23], v1 offset:21120
    ds_read_b64 v[24:25], v1 offset:21248
    ds_read_b64 v[26:27], v1 offset:21376
    ds_read_b64 v[28:29], v1 offset:21504
    ds_read_b64 v[30:31], v1 offset:21632
    s_waitcnt lgkmcnt(0)
    v_add_f32 v16, v16, v18
    v_add_f32 v17, v17, v19
    v_add_f32 v16, v16, v20
    v_add_f32 v17, v17, v21
    v_add_f32 v16, v16, v22
    v_add_f32 v17, v17, v23
    v_add_f32 v16, v16, v24
    v_add_f32 v17, v17, v25
    v_add_f32 v16, v16, v26
    v_add_f32 v17, v17, v27
    v_add_f32 v16, v16, v28
    v_add_f32 v17, v17, v29
    v_add_f32 v16, v16, v30
    v_add_f32 v17, v17, v31
    v_cvt_pk_bf16_f32 v2, v16, v17
    v_mov_b32 v3, s80
    v_lshrrev_b32 v4, 3, v0
    v_lshlrev_b32 v4, 11, v4
    v_and_b32 v5, 7, v0
    v_add_u32 v4, v4, v5
    v_lshlrev_b32 v4, 3, v4
    s_lshl_b32 s52, s97, 6
    buffer_store_dwordx2 v[2:3], v4, s[44:47], s52 offen offset:0 sc0 sc1
    s_mov_b64 exec, s[82:83]
    v_lshlrev_b32 v4, 3, v0
    s_lshl_b32 s52, s54, 11
    s_mov_b32 s81, 100000
Lpoll1:
    buffer_load_dwordx2 v[2:3], v4, s[44:47], s52 offen offset:0 sc0 sc1
    s_waitcnt vmcnt(0)
    v_cmp_ne_u32 vcc, s80, v3
    s_cbranch_vccz Lpoll1_ok
    s_sleep 1
    s_sub_u32 s81, s81, 1
    s_cmp_eq_u32 s81, 0
    s_cbranch_scc0 Lpoll1
Lpoll1_ok:
    v_add_u32 v15, 0, v14
    v_and_b32 v15, 15, v15
    v_lshl_add_u32 v15, v15, 12, v13
    buffer_load_dwordx4 v[112:115], v15, s[20:23], s56 offen offset:0
    buffer_load_dwordx4 v[116:119], v15, s[20:23], s56 offen offset:1024
    buffer_load_dwordx4 v[120:123], v15, s[20:23], s56 offen offset:2048
    buffer_load_dwordx4 v[124:127], v15, s[20:23], s56 offen offset:3072
    v_add_u32 v15, 1, v14
    v_and_b32 v15, 15, v15
    v_lshl_add_u32 v15, v15, 12, v13
    buffer_load_dwordx4 v[128:131], v15, s[20:23], s56 offen offset:0
    buffer_load_dwordx4 v[132:135], v15, s[20:23], s56 offen offset:1024
    buffer_load_dwordx4 v[136:139], v15, s[20:23], s56 offen offset:2048
    buffer_load_dwordx4 v[140:143], v15, s[20:23], s56 offen offset:3072
    v_add_u32 v15, 2, v14
    v_and_b32 v15, 15, v15
    v_lshl_add_u32 v15, v15, 12, v13
    buffer_load_dwordx4 v[144:147], v15, s[20:23], s56 offen offset:0
    buffer_load_dwordx4 v[148:151], v15, s[20:23], s56 offen offset:1024
    buffer_load_dwordx4 v[152:155], v15, s[20:23], s56 offen offset:2048
    buffer_load_dwordx4 v[156:159], v15, s[20:23], s56 offen offset:3072
    v_add_u32 v15, 3, v14
    v_and_b32 v15, 15, v15
    v_lshl_add_u32 v15, v15, 12, v13
    buffer_load_dwordx4 v[160:163], v15, s[20:23], s56 offen offset:0
    buffer_load_dwordx4 v[164:167], v15, s[20:23], s56 offen offset:1024
    buffer_load_dwordx4 v[168:171], v15, s[20:23], s56 offen offset:2048
    buffer_load_dwordx4 v[172:175], v15, s[20:23], s56 offen offset:3072
    s_lshr_b32 s58, s2, 3
    s_and_b32 s59, s2, 7
    v_lshrrev_b32 v6, 3, v0
    v_lshlrev_b32 v6, 10, v6
    v_and_b32 v7, 7, v0
    v_lshl_add_u32 v6, v7, 4, v6
    s_lshl_b32 s52, s58, 17
    s_lshl_b32 s53, s59, 7
    s_add_u32 s52, s52, s53
    buffer_load_dwordx4 v[176:179], v6, s[24:27], s52 offen
    s_add_u32 s52, s52, 32768
    buffer_load_dwordx4 v[180:183], v6, s[24:27], s52 offen
    s_add_u32 s52, s52, 32768
    buffer_load_dwordx4 v[184:187], v6, s[24:27], s52 offen
    s_add_u32 s52, s52, 32768
    buffer_load_dwordx4 v[188:191], v6, s[24:27], s52 offen
    s_add_u32 s52, s52, 32768
    s_cmp_ge_u32 s6, 224
    s_cbranch_scc1 L_nogu
    s_movk_i32 s3, 3584
    v_mul_lo_u32 v6, v0, s3
    s_lshl_b32 s52, s6, 4
    buffer_load_dwordx4 v[192:195], v6, s[28:31], s52 offen
    buffer_load_dwordx4 v[200:203], v6, s[32:35], s52 offen
    s_add_u32 s52, s52, 917504
    buffer_load_dwordx4 v[196:199], v6, s[28:31], s52 offen
    buffer_load_dwordx4 v[204:207], v6, s[32:35], s52 offen
    s_add_u32 s52, s52, 917504
L_nogu:
    s_cmp_lt_u32 s2, 192
    s_cbranch_scc1 L_nowd
    v_lshlrev_b32 v6, 10, v0
    s_mov_b32 s52, s7
    s_lshl_b32 s52, s52, 4
    buffer_load_dwordx4 v[208:211], v6, s[36:39], s52 offen
    s_add_u32 s52, s52, 262144
    buffer_load_dwordx4 v[212:215], v6, s[36:39], s52 offen
    s_add_u32 s52, s52, 262144
    buffer_load_dwordx4 v[216:219], v6, s[36:39], s52 offen
    s_add_u32 s52, s52, 262144
    buffer_load_dwordx4 v[220:223], v6, s[36:39], s52 offen
    s_add_u32 s52, s52, 262144
    buffer_load_dwordx4 v[224:227], v6, s[36:39], s52 offen
    s_add_u32 s52, s52, 262144
    buffer_load_dwordx4 v[228:231], v6, s[36:39], s52 offen
    s_add_u32 s52, s52, 262144
    buffer_load_dwordx4 v[232:235], v6, s[36:39], s52 offen
    s_add_u32 s52, s52, 262144
L_nowd:
    s_barrier
    v_lshlrev_b32 v1, 2, v0
    ds_write_b32 v1, v2 offset:0
    s_waitcnt lgkmcnt(0)
    s_barrier
    v_lshlrev_b32 v1, 8, v10
    v_lshl_add_u32 v1, v11, 4, v1
    ds_read_b128 v[16:19], v1 offset:0
    ds_read_b128 v[20:23], v1 offset:64
    ds_read_b128 v[24:27], v1 offset:128
    ds_read_b128 v[28:31], v1 offset:192
    s_waitcnt lgkmcnt(0)
    v_cmp_gt_u32 vcc, 4, v10
    s_nop 1
    v_cndmask_b32 v16, 0, v16, vcc
    v_cndmask_b32 v17, 0, v17, vcc
    v_cndmask_b32 v18, 0, v18, vcc
    v_cndmask_b32 v19, 0, v19, vcc
    v_cndmask_b32 v20, 0, v20, vcc
    v_cndmask_b32 v21, 0, v21, vcc
    v_cndmask_b32 v22, 0, v22, vcc
    v_cndmask_b32 v23, 0, v23, vcc
    v_cndmask_b32 v24, 0, v24, vcc
    v_cndmask_b32 v25, 0, v25, vcc
    v_cndmask_b32 v26, 0, v26, vcc
    v_cndmask_b32 v27, 0, v27, vcc
    v_cndmask_b32 v28, 0, v28, vcc
    v_cndmask_b32 v29, 0, v29, vcc
    v_cndmask_b32 v30, 0, v30, vcc
    v_cndmask_b32 v31, 0, v31, vcc
    v_mov_b32 v236, 0
    v_mov_b32 v237, 0
    v_mov_b32 v238, 0
    v_mov_b32 v239, 0
    v_mov_b32 v240, 0
    v_mov_b32 v241, 0
    v_mov_b32 v242, 0
    v_mov_b32 v243, 0
    v_mov_b32 v244, 0
    v_mov_b32 v245, 0
    v_mov_b32 v246, 0
    v_mov_b32 v247, 0
    v_mov_b32 v248, 0
    v_mov_b32 v249, 0
    v_mov_b32 v250, 0
    v_mov_b32 v251, 0
    s_nop 1
    v_mfma_f32_16x16x32_bf16 v[236:239], v[16:19], v[48:51], v[236:239]
    v_mfma_f32_16x16x32_bf16 v[236:239], v[20:23], v[52:55], v[236:239]
    v_mfma_f32_16x16x32_bf16 v[236:239], v[24:27], v[56:59], v[236:239]
    v_mfma_f32_16x16x32_bf16 v[236:239], v[28:31], v[60:63], v[236:239]
    v_mfma_f32_16x16x32_bf16 v[240:243], v[16:19], v[64:67], v[240:243]
    v_mfma_f32_16x16x32_bf16 v[240:243], v[20:23], v[68:71], v[240:243]
    v_mfma_f32_16x16x32_bf16 v[240:243], v[24:27], v[72:75], v[240:243]
    v_mfma_f32_16x16x32_bf16 v[240:243], v[28:31], v[76:79], v[240:243]
    v_mfma_f32_16x16x32_bf16 v[244:247], v[16:19], v[80:83], v[244:247]
    v_mfma_f32_16x16x32_bf16 v[244:247], v[20:23], v[84:87], v[244:247]
    v_mfma_f32_16x16x32_bf16 v[244:247], v[24:27], v[88:91], v[244:247]
    v_mfma_f32_16x16x32_bf16 v[244:247], v[28:31], v[92:95], v[244:247]
    v_mfma_f32_16x16x32_bf16 v[248:251], v[16:19], v[96:99], v[248:251]
    v_mfma_f32_16x16x32_bf16 v[248:251], v[20:23], v[100:103], v[248:251]
    v_mfma_f32_16x16x32_bf16 v[248:251], v[24:27], v[104:107], v[248:251]
    v_mfma_f32_16x16x32_bf16 v[248:251], v[28:31], v[108:111], v[248:251]
    s_nop 7
    s_nop 1
    s_mov_b32 s52, 0x3e0293ee
    v_mul_f32 v236, s52, v236
    v_mul_f32 v237, s52, v237
    v_mul_f32 v238, s52, v238
    v_mul_f32 v239, s52, v239
    v_mul_f32 v240, s52, v240
    v_mul_f32 v241, s52, v241
    v_mul_f32 v242, s52, v242
    v_mul_f32 v243, s52, v243
    v_mul_f32 v244, s52, v244
    v_mul_f32 v245, s52, v245
    v_mul_f32 v246, s52, v246
    v_mul_f32 v247, s52, v247
    v_mul_f32 v248, s52, v248
    v_mul_f32 v249, s52, v249
    v_mul_f32 v250, s52, v250
    v_mul_f32 v251, s52, v251
    v_max_f32 v48, v236, v240
    v_max3_f32 v48, v48, v244, v248
    v_max_f32 v49, v237, v241
    v_max3_f32 v49, v49, v245, v249
    v_max_f32 v50, v238, v242
    v_max3_f32 v50, v50, v246, v250
    v_max_f32 v51, v239, v243
    v_max3_f32 v51, v51, v247, v251
    s_nop 1
    v_max_f32_dpp v48, v48, v48 row_ror:8 row_mask:0xf bank_mask:0xf
    v_max_f32_dpp v49, v49, v49 row_ror:8 row_mask:0xf bank_mask:0xf
    v_max_f32_dpp v50, v50, v50 row_ror:8 row_mask:0xf bank_mask:0xf
    v_max_f32_dpp v51, v51, v51 row_ror:8 row_mask:0xf bank_mask:0xf
    s_nop 1
    v_max_f32_dpp v48, v48, v48 row_ror:4 row_mask:0xf bank_mask:0xf
    v_max_f32_dpp v49, v49, v49 row_ror:4 row_mask:0xf bank_mask:0xf
    v_max_f32_dpp v50, v50, v50 row_ror:4 row_mask:0xf bank_mask:0xf
    v_max_f32_dpp v51, v51, v51 row_ror:4 row_mask:0xf bank_mask:0xf
    s_nop 1
    v_max_f32_dpp v48, v48, v48 row_ror:2 row_mask:0xf bank_mask:0xf
    v_max_f32_dpp v49, v49, v49 row_ror:2 row_mask:0xf bank_mask:0xf
    v_max_f32_dpp v50, v50, v50 row_ror:2 row_mask:0xf bank_mask:0xf
    v_max_f32_dpp v51, v51, v51 row_ror:2 row_mask:0xf bank_mask:0xf
    s_nop 1
    v_max_f32_dpp v48, v48, v48 row_ror:1 row_mask:0xf bank_mask:0xf
    v_max_f32_dpp v49, v49, v49 row_ror:1 row_mask:0xf bank_mask:0xf
    v_max_f32_dpp v50, v50, v50 row_ror:1 row_mask:0xf bank_mask:0xf
    v_max_f32_dpp v51, v51, v51 row_ror:1 row_mask:0xf bank_mask:0xf
    v_lshlrev_b32 v1, 4, v8
    v_cmp_eq_u32 vcc, 0, v9
    s_and_saveexec_b64 s[82:83], vcc
    ds_write_b128 v1, v[48:51] offset:5120
    s_mov_b64 exec, s[82:83]
    s_waitcnt lgkmcnt(0)
    s_barrier
    v_mov_b32 v1, 0
    ds_read_b128 v[52:55], v1 offset:5120
    ds_read_b128 v[56:59], v1 offset:5136
    ds_read_b128 v[60:63], v1 offset:5152
    ds_read_b128 v[64:67], v1 offset:5168
    s_waitcnt lgkmcnt(0)
    v_max_f32 v48, v52, v56
    v_max3_f32 v48, v48, v60, v64
    v_max_f32 v49, v53, v57
    v_max3_f32 v49, v49, v61, v65
    v_max_f32 v50, v54, v58
    v_max3_f32 v50, v50, v62, v66
    v_max_f32 v51, v55, v59
    v_max3_f32 v51, v51, v63, v67
    v_sub_f32 v236, v236, v48
    v_exp_f32 v236, v236
    v_sub_f32 v237, v237, v49
    v_exp_f32 v237, v237
    v_sub_f32 v238, v238, v50
    v_exp_f32 v238, v238
    v_sub_f32 v239, v239, v51
    v_exp_f32 v239, v239
    v_sub_f32 v240, v240, v48
    v_exp_f32 v240, v240
    v_sub_f32 v241, v241, v49
    v_exp_f32 v241, v241
    v_sub_f32 v242, v242, v50
    v_exp_f32 v242, v242
    v_sub_f32 v243, v243, v51
    v_exp_f32 v243, v243
    v_sub_f32 v244, v244, v48
    v_exp_f32 v244, v244
    v_sub_f32 v245, v245, v49
    v_exp_f32 v245, v245
    v_sub_f32 v246, v246, v50
    v_exp_f32 v246, v246
    v_sub_f32 v247, v247, v51
    v_exp_f32 v247, v247
    v_sub_f32 v248, v248, v48
    v_exp_f32 v248, v248
    v_sub_f32 v249, v249, v49
    v_exp_f32 v249, v249
    v_sub_f32 v250, v250, v50
    v_exp_f32 v250, v250
    v_sub_f32 v251, v251, v51
    v_exp_f32 v251, v251
    s_nop 0
    v_add_f32 v52, v236, v240
    v_add_f32 v56, v244, v248
    v_add_f32 v52, v52, v56
    v_add_f32 v53, v237, v241
    v_add_f32 v57, v245, v249
    v_add_f32 v53, v53, v57
    v_add_f32 v54, v238, v242
    v_add_f32 v58, v246, v250
    v_add_f32 v54, v54, v58
    v_add_f32 v55, v239, v243
    v_add_f32 v59, v247, v251
    v_add_f32 v55, v55, v59
    s_nop 1
    v_add_f32_dpp v52, v52, v52 row_ror:8 row_mask:0xf bank_mask:0xf
    v_add_f32_dpp v53, v53, v53 row_ror:8 row_mask:0xf bank_mask:0xf
    v_add_f32_dpp v54, v54, v54 row_ror:8 row_mask:0xf bank_mask:0xf
    v_add_f32_dpp v55, v55, v55 row_ror:8 row_mask:0xf bank_mask:0xf
    s_nop 1
    v_add_f32_dpp v52, v52, v52 row_ror:4 row_mask:0xf bank_mask:0xf
    v_add_f32_dpp v53, v53, v53 row_ror:4 row_mask:0xf bank_mask:0xf
    v_add_f32_dpp v54, v54, v54 row_ror:4 row_mask:0xf bank_mask:0xf
    v_add_f32_dpp v55, v55, v55 row_ror:4 row_mask:0xf bank_mask:0xf
    s_nop 1
    v_add_f32_dpp v52, v52, v52 row_ror:2 row_mask:0xf bank_mask:0xf
    v_add_f32_dpp v53, v53, v53 row_ror:2 row_mask:0xf bank_mask:0xf
    v_add_f32_dpp v54, v54, v54 row_ror:2 row_mask:0xf bank_mask:0xf
    v_add_f32_dpp v55, v55, v55 row_ror:2 row_mask:0xf bank_mask:0xf
    s_nop 1
    v_add_f32_dpp v52, v52, v52 row_ror:1 row_mask:0xf bank_mask:0xf
    v_add_f32_dpp v53, v53, v53 row_ror:1 row_mask:0xf bank_mask:0xf
    v_add_f32_dpp v54, v54, v54 row_ror:1 row_mask:0xf bank_mask:0xf
    v_add_f32_dpp v55, v55, v55 row_ror:1 row_mask:0xf bank_mask:0xf
    v_lshlrev_b32 v1, 10, v8
    v_lshl_add_u32 v1, v9, 4, v1
    v_lshlrev_b32 v2, 4, v8
    v_cmp_gt_u32 vcc, 16, v9
    s_and_saveexec_b64 s[82:83], vcc
    ds_write_b128 v1, v[236:239] offset:1024
    ds_write_b128 v1, v[240:243] offset:1280
    ds_write_b128 v1, v[244:247] offset:1536
    ds_write_b128 v1, v[248:251] offset:1792
    v_cmp_eq_u32 vcc, 0, v9
    s_and_saveexec_b64 s[84:85], vcc
    ds_write_b128 v2, v[52:55] offset:5184
    s_mov_b64 exec, s[82:83]
    s_waitcnt lgkmcnt(0)
    s_barrier
    v_mov_b32 v64, 0
    v_mov_b32 v65, 0
    v_mov_b32 v66, 0
    v_mov_b32 v67, 0
    v_mov_b32 v68, 0
    v_mov_b32 v69, 0
    v_mov_b32 v70, 0
    v_mov_b32 v71, 0
    v_mov_b32 v72, 0
    v_mov_b32 v73, 0
    v_mov_b32 v74, 0
    v_mov_b32 v75, 0
    v_mov_b32 v76, 0
    v_mov_b32 v77, 0
    v_mov_b32 v78, 0
    v_mov_b32 v79, 0
    v_mov_b32 v80, 0
    v_mov_b32 v81, 0
    v_mov_b32 v82, 0
    v_mov_b32 v83, 0
    v_mov_b32 v84, 0
    v_mov_b32 v85, 0
    v_mov_b32 v86, 0
    v_mov_b32 v87, 0
    v_mov_b32 v88, 0
    v_mov_b32 v89, 0
    v_mov_b32 v90, 0
    v_mov_b32 v91, 0
    v_mov_b32 v92, 0
    v_mov_b32 v93, 0
    v_mov_b32 v94, 0
    v_mov_b32 v95, 0
    v_lshlrev_b32 v1, 10, v8
    v_lshl_add_u32 v1, v11, 4, v1
    ds_read_b128 v[236:239], v1 offset:1024
    s_waitcnt vmcnt(19)
    v_lshlrev_b32 v16, 16, v112
    v_and_b32 v17, 0xffff0000, v112
    v_lshlrev_b32 v18, 16, v113
    v_and_b32 v19, 0xffff0000, v113
    v_lshlrev_b32 v20, 16, v114
    v_and_b32 v21, 0xffff0000, v114
    v_lshlrev_b32 v22, 16, v115
    v_and_b32 v23, 0xffff0000, v115
    s_waitcnt lgkmcnt(0)
    v_fmac_f32 v64, v236, v16
    v_fmac_f32 v65, v236, v17
    v_fmac_f32 v66, v236, v18
    v_fmac_f32 v67, v236, v19
    v_fmac_f32 v68, v236, v20
    v_fmac_f32 v69, v236, v21
    v_fmac_f32 v70, v236, v22
    v_fmac_f32 v71, v236, v23
    v_fmac_f32 v72, v237, v16
    v_fmac_f32 v73, v237, v17
    v_fmac_f32 v74, v237, v18
    v_fmac_f32 v75, v237, v19
    v_fmac_f32 v76, v237, v20
    v_fmac_f32 v77, v237, v21
    v_fmac_f32 v78, v237, v22
    v_fmac_f32 v79, v237, v23
    v_fmac_f32 v80, v238, v16
    v_fmac_f32 v81, v238, v17
    v_fmac_f32 v82, v238, v18
    v_fmac_f32 v83, v238, v19
    v_fmac_f32 v84, v238, v20
    v_fmac_f32 v85, v238, v21
    v_fmac_f32 v86, v238, v22
    v_fmac_f32 v87, v238, v23
    v_fmac_f32 v88, v239, v16
    v_fmac_f32 v89, v239, v17
    v_fmac_f32 v90, v239, v18
    v_fmac_f32 v91, v239, v19
    v_fmac_f32 v92, v239, v20
    v_fmac_f32 v93, v239, v21
    v_fmac_f32 v94, v239, v22
    v_fmac_f32 v95, v239, v23
    ds_read_b128 v[236:239], v1 offset:1088
    s_waitcnt vmcnt(18)
    v_lshlrev_b32 v16, 16, v116
    v_and_b32 v17, 0xffff0000, v116
    v_lshlrev_b32 v18, 16, v117
    v_and_b32 v19, 0xffff0000, v117
    v_lshlrev_b32 v20, 16, v118
    v_and_b32 v21, 0xffff0000, v118
    v_lshlrev_b32 v22, 16, v119
    v_and_b32 v23, 0xffff0000, v119
    s_waitcnt lgkmcnt(0)
    v_fmac_f32 v64, v236, v16
    v_fmac_f32 v65, v236, v17
    v_fmac_f32 v66, v236, v18
    v_fmac_f32 v67, v236, v19
    v_fmac_f32 v68, v236, v20
    v_fmac_f32 v69, v236, v21
    v_fmac_f32 v70, v236, v22
    v_fmac_f32 v71, v236, v23
    v_fmac_f32 v72, v237, v16
    v_fmac_f32 v73, v237, v17
    v_fmac_f32 v74, v237, v18
    v_fmac_f32 v75, v237, v19
    v_fmac_f32 v76, v237, v20
    v_fmac_f32 v77, v237, v21
    v_fmac_f32 v78, v237, v22
    v_fmac_f32 v79, v237, v23
    v_fmac_f32 v80, v238, v16
    v_fmac_f32 v81, v238, v17
    v_fmac_f32 v82, v238, v18
    v_fmac_f32 v83, v238, v19
    v_fmac_f32 v84, v238, v20
    v_fmac_f32 v85, v238, v21
    v_fmac_f32 v86, v238, v22
    v_fmac_f32 v87, v238, v23
    v_fmac_f32 v88, v239, v16
    v_fmac_f32 v89, v239, v17
    v_fmac_f32 v90, v239, v18
    v_fmac_f32 v91, v239, v19
    v_fmac_f32 v92, v239, v20
    v_fmac_f32 v93, v239, v21
    v_fmac_f32 v94, v239, v22
    v_fmac_f32 v95, v239, v23
    ds_read_b128 v[236:239], v1 offset:1152
    s_waitcnt vmcnt(17)
    v_lshlrev_b32 v16, 16, v120
    v_and_b32 v17, 0xffff0000, v120
    v_lshlrev_b32 v18, 16, v121
    v_and_b32 v19, 0xffff0000, v121
    v_lshlrev_b32 v20, 16, v122
    v_and_b32 v21, 0xffff0000, v122
    v_lshlrev_b32 v22, 16, v123
    v_and_b32 v23, 0xffff0000, v123
    s_waitcnt lgkmcnt(0)
    v_fmac_f32 v64, v236, v16
    v_fmac_f32 v65, v236, v17
    v_fmac_f32 v66, v236, v18
    v_fmac_f32 v67, v236, v19
    v_fmac_f32 v68, v236, v20
    v_fmac_f32 v69, v236, v21
    v_fmac_f32 v70, v236, v22
    v_fmac_f32 v71, v236, v23
    v_fmac_f32 v72, v237, v16
    v_fmac_f32 v73, v237, v17
    v_fmac_f32 v74, v237, v18
    v_fmac_f32 v75, v237, v19
    v_fmac_f32 v76, v237, v20
    v_fmac_f32 v77, v237, v21
    v_fmac_f32 v78, v237, v22
    v_fmac_f32 v79, v237, v23
    v_fmac_f32 v80, v238, v16
    v_fmac_f32 v81, v238, v17
    v_fmac_f32 v82, v238, v18
    v_fmac_f32 v83, v238, v19
    v_fmac_f32 v84, v238, v20
    v_fmac_f32 v85, v238, v21
    v_fmac_f32 v86, v238, v22
    v_fmac_f32 v87, v238, v23
    v_fmac_f32 v88, v239, v16
    v_fmac_f32 v89, v239, v17
    v_fmac_f32 v90, v239, v18
    v_fmac_f32 v91, v239, v19
    v_fmac_f32 v92, v239, v20
    v_fmac_f32 v93, v239, v21
    v_fmac_f32 v94, v239, v22
    v_fmac_f32 v95, v239, v23
    ds_read_b128 v[236:239], v1 offset:1216
    s_waitcnt vmcnt(16)
    v_lshlrev_b32 v16, 16, v124
    v_and_b32 v17, 0xffff0000, v124
    v_lshlrev_b32 v18, 16, v125
    v_and_b32 v19, 0xffff0000, v125
    v_lshlrev_b32 v20, 16, v126
    v_and_b32 v21, 0xffff0000, v126
    v_lshlrev_b32 v22, 16, v127
    v_and_b32 v23, 0xffff0000, v127
    s_waitcnt lgkmcnt(0)
    v_fmac_f32 v64, v236, v16
    v_fmac_f32 v65, v236, v17
    v_fmac_f32 v66, v236, v18
    v_fmac_f32 v67, v236, v19
    v_fmac_f32 v68, v236, v20
    v_fmac_f32 v69, v236, v21
    v_fmac_f32 v70, v236, v22
    v_fmac_f32 v71, v236, v23
    v_fmac_f32 v72, v237, v16
    v_fmac_f32 v73, v237, v17
    v_fmac_f32 v74, v237, v18
    v_fmac_f32 v75, v237, v19
    v_fmac_f32 v76, v237, v20
    v_fmac_f32 v77, v237, v21
    v_fmac_f32 v78, v237, v22
    v_fmac_f32 v79, v237, v23
    v_fmac_f32 v80, v238, v16
    v_fmac_f32 v81, v238, v17
    v_fmac_f32 v82, v238, v18
    v_fmac_f32 v83, v238, v19
    v_fmac_f32 v84, v238, v20
    v_fmac_f32 v85, v238, v21
    v_fmac_f32 v86, v238, v22
    v_fmac_f32 v87, v238, v23
    v_fmac_f32 v88, v239, v16
    v_fmac_f32 v89, v239, v17
    v_fmac_f32 v90, v239, v18
    v_fmac_f32 v91, v239, v19
    v_fmac_f32 v92, v239, v20
    v_fmac_f32 v93, v239, v21
    v_fmac_f32 v94, v239, v22
    v_fmac_f32 v95, v239, v23
    ds_read_b128 v[236:239], v1 offset:1280
    s_waitcnt vmcnt(15)
    v_lshlrev_b32 v16, 16, v128
    v_and_b32 v17, 0xffff0000, v128
    v_lshlrev_b32 v18, 16, v129
    v_and_b32 v19, 0xffff0000, v129
    v_lshlrev_b32 v20, 16, v130
    v_and_b32 v21, 0xffff0000, v130
    v_lshlrev_b32 v22, 16, v131
    v_and_b32 v23, 0xffff0000, v131
    s_waitcnt lgkmcnt(0)
    v_fmac_f32 v64, v236, v16
    v_fmac_f32 v65, v236, v17
    v_fmac_f32 v66, v236, v18
    v_fmac_f32 v67, v236, v19
    v_fmac_f32 v68, v236, v20
    v_fmac_f32 v69, v236, v21
    v_fmac_f32 v70, v236, v22
    v_fmac_f32 v71, v236, v23
    v_fmac_f32 v72, v237, v16
    v_fmac_f32 v73, v237, v17
    v_fmac_f32 v74, v237, v18
    v_fmac_f32 v75, v237, v19
    v_fmac_f32 v76, v237, v20
    v_fmac_f32 v77, v237, v21
    v_fmac_f32 v78, v237, v22
    v_fmac_f32 v79, v237, v23
    v_fmac_f32 v80, v238, v16
    v_fmac_f32 v81, v238, v17
    v_fmac_f32 v82, v238, v18
    v_fmac_f32 v83, v238, v19
    v_fmac_f32 v84, v238, v20
    v_fmac_f32 v85, v238, v21
    v_fmac_f32 v86, v238, v22
    v_fmac_f32 v87, v238, v23
    v_fmac_f32 v88, v239, v16
    v_fmac_f32 v89, v239, v17
    v_fmac_f32 v90, v239, v18
    v_fmac_f32 v91, v239, v19
    v_fmac_f32 v92, v239, v20
    v_fmac_f32 v93, v239, v21
    v_fmac_f32 v94, v239, v22
    v_fmac_f32 v95, v239, v23
    ds_read_b128 v[236:239], v1 offset:1344
    s_waitcnt vmcnt(14)
    v_lshlrev_b32 v16, 16, v132
    v_and_b32 v17, 0xffff0000, v132
    v_lshlrev_b32 v18, 16, v133
    v_and_b32 v19, 0xffff0000, v133
    v_lshlrev_b32 v20, 16, v134
    v_and_b32 v21, 0xffff0000, v134
    v_lshlrev_b32 v22, 16, v135
    v_and_b32 v23, 0xffff0000, v135
    s_waitcnt lgkmcnt(0)
    v_fmac_f32 v64, v236, v16
    v_fmac_f32 v65, v236, v17
    v_fmac_f32 v66, v236, v18
    v_fmac_f32 v67, v236, v19
    v_fmac_f32 v68, v236, v20
    v_fmac_f32 v69, v236, v21
    v_fmac_f32 v70, v236, v22
    v_fmac_f32 v71, v236, v23
    v_fmac_f32 v72, v237, v16
    v_fmac_f32 v73, v237, v17
    v_fmac_f32 v74, v237, v18
    v_fmac_f32 v75, v237, v19
    v_fmac_f32 v76, v237, v20
    v_fmac_f32 v77, v237, v21
    v_fmac_f32 v78, v237, v22
    v_fmac_f32 v79, v237, v23
    v_fmac_f32 v80, v238, v16
    v_fmac_f32 v81, v238, v17
    v_fmac_f32 v82, v238, v18
    v_fmac_f32 v83, v238, v19
    v_fmac_f32 v84, v238, v20
    v_fmac_f32 v85, v238, v21
    v_fmac_f32 v86, v238, v22
    v_fmac_f32 v87, v238, v23
    v_fmac_f32 v88, v239, v16
    v_fmac_f32 v89, v239, v17
    v_fmac_f32 v90, v239, v18
    v_fmac_f32 v91, v239, v19
    v_fmac_f32 v92, v239, v20
    v_fmac_f32 v93, v239, v21
    v_fmac_f32 v94, v239, v22
    v_fmac_f32 v95, v239, v23
    ds_read_b128 v[236:239], v1 offset:1408
    s_waitcnt vmcnt(13)
    v_lshlrev_b32 v16, 16, v136
    v_and_b32 v17, 0xffff0000, v136
    v_lshlrev_b32 v18, 16, v137
    v_and_b32 v19, 0xffff0000, v137
    v_lshlrev_b32 v20, 16, v138
    v_and_b32 v21, 0xffff0000, v138
    v_lshlrev_b32 v22, 16, v139
    v_and_b32 v23, 0xffff0000, v139
    s_waitcnt lgkmcnt(0)
    v_fmac_f32 v64, v236, v16
    v_fmac_f32 v65, v236, v17
    v_fmac_f32 v66, v236, v18
    v_fmac_f32 v67, v236, v19
    v_fmac_f32 v68, v236, v20
    v_fmac_f32 v69, v236, v21
    v_fmac_f32 v70, v236, v22
    v_fmac_f32 v71, v236, v23
    v_fmac_f32 v72, v237, v16
    v_fmac_f32 v73, v237, v17
    v_fmac_f32 v74, v237, v18
    v_fmac_f32 v75, v237, v19
    v_fmac_f32 v76, v237, v20
    v_fmac_f32 v77, v237, v21
    v_fmac_f32 v78, v237, v22
    v_fmac_f32 v79, v237, v23
    v_fmac_f32 v80, v238, v16
    v_fmac_f32 v81, v238, v17
    v_fmac_f32 v82, v238, v18
    v_fmac_f32 v83, v238, v19
    v_fmac_f32 v84, v238, v20
    v_fmac_f32 v85, v238, v21
    v_fmac_f32 v86, v238, v22
    v_fmac_f32 v87, v238, v23
    v_fmac_f32 v88, v239, v16
    v_fmac_f32 v89, v239, v17
    v_fmac_f32 v90, v239, v18
    v_fmac_f32 v91, v239, v19
    v_fmac_f32 v92, v239, v20
    v_fmac_f32 v93, v239, v21
    v_fmac_f32 v94, v239, v22
    v_fmac_f32 v95, v239, v23
    ds_read_b128 v[236:239], v1 offset:1472
    s_waitcnt vmcnt(12)
    v_lshlrev_b32 v16, 16, v140
    v_and_b32 v17, 0xffff0000, v140
    v_lshlrev_b32 v18, 16, v141
    v_and_b32 v19, 0xffff0000, v141
    v_lshlrev_b32 v20, 16, v142
    v_and_b32 v21, 0xffff0000, v142
    v_lshlrev_b32 v22, 16, v143
    v_and_b32 v23, 0xffff0000, v143
    s_waitcnt lgkmcnt(0)
    v_fmac_f32 v64, v236, v16
    v_fmac_f32 v65, v236, v17
    v_fmac_f32 v66, v236, v18
    v_fmac_f32 v67, v236, v19
    v_fmac_f32 v68, v236, v20
    v_fmac_f32 v69, v236, v21
    v_fmac_f32 v70, v236, v22
    v_fmac_f32 v71, v236, v23
    v_fmac_f32 v72, v237, v16
    v_fmac_f32 v73, v237, v17
    v_fmac_f32 v74, v237, v18
    v_fmac_f32 v75, v237, v19
    v_fmac_f32 v76, v237, v20
    v_fmac_f32 v77, v237, v21
    v_fmac_f32 v78, v237, v22
    v_fmac_f32 v79, v237, v23
    v_fmac_f32 v80, v238, v16
    v_fmac_f32 v81, v238, v17
    v_fmac_f32 v82, v238, v18
    v_fmac_f32 v83, v238, v19
    v_fmac_f32 v84, v238, v20
    v_fmac_f32 v85, v238, v21
    v_fmac_f32 v86, v238, v22
    v_fmac_f32 v87, v238, v23
    v_fmac_f32 v88, v239, v16
    v_fmac_f32 v89, v239, v17
    v_fmac_f32 v90, v239, v18
    v_fmac_f32 v91, v239, v19
    v_fmac_f32 v92, v239, v20
    v_fmac_f32 v93, v239, v21
    v_fmac_f32 v94, v239, v22
    v_fmac_f32 v95, v239, v23
    ds_read_b128 v[236:239], v1 offset:1536
    s_waitcnt vmcnt(11)
    v_lshlrev_b32 v16, 16, v144
    v_and_b32 v17, 0xffff0000, v144
    v_lshlrev_b32 v18, 16, v145
    v_and_b32 v19, 0xffff0000, v145
    v_lshlrev_b32 v20, 16, v146
    v_and_b32 v21, 0xffff0000, v146
    v_lshlrev_b32 v22, 16, v147
    v_and_b32 v23, 0xffff0000, v147
    s_waitcnt lgkmcnt(0)
    v_fmac_f32 v64, v236, v16
    v_fmac_f32 v65, v236, v17
    v_fmac_f32 v66, v236, v18
    v_fmac_f32 v67, v236, v19
    v_fmac_f32 v68, v236, v20
    v_fmac_f32 v69, v236, v21
    v_fmac_f32 v70, v236, v22
    v_fmac_f32 v71, v236, v23
    v_fmac_f32 v72, v237, v16
    v_fmac_f32 v73, v237, v17
    v_fmac_f32 v74, v237, v18
    v_fmac_f32 v75, v237, v19
    v_fmac_f32 v76, v237, v20
    v_fmac_f32 v77, v237, v21
    v_fmac_f32 v78, v237, v22
    v_fmac_f32 v79, v237, v23
    v_fmac_f32 v80, v238, v16
    v_fmac_f32 v81, v238, v17
    v_fmac_f32 v82, v238, v18
    v_fmac_f32 v83, v238, v19
    v_fmac_f32 v84, v238, v20
    v_fmac_f32 v85, v238, v21
    v_fmac_f32 v86, v238, v22
    v_fmac_f32 v87, v238, v23
    v_fmac_f32 v88, v239, v16
    v_fmac_f32 v89, v239, v17
    v_fmac_f32 v90, v239, v18
    v_fmac_f32 v91, v239, v19
    v_fmac_f32 v92, v239, v20
    v_fmac_f32 v93, v239, v21
    v_fmac_f32 v94, v239, v22
    v_fmac_f32 v95, v239, v23
    ds_read_b128 v[236:239], v1 offset:1600
    s_waitcnt vmcnt(10)
    v_lshlrev_b32 v16, 16, v148
    v_and_b32 v17, 0xffff0000, v148
    v_lshlrev_b32 v18, 16, v149
    v_and_b32 v19, 0xffff0000, v149
    v_lshlrev_b32 v20, 16, v150
    v_and_b32 v21, 0xffff0000, v150
    v_lshlrev_b32 v22, 16, v151
    v_and_b32 v23, 0xffff0000, v151
    s_waitcnt lgkmcnt(0)
    v_fmac_f32 v64, v236, v16
    v_fmac_f32 v65, v236, v17
    v_fmac_f32 v66, v236, v18
    v_fmac_f32 v67, v236, v19
    v_fmac_f32 v68, v236, v20
    v_fmac_f32 v69, v236, v21
    v_fmac_f32 v70, v236, v22
    v_fmac_f32 v71, v236, v23
    v_fmac_f32 v72, v237, v16
    v_fmac_f32 v73, v237, v17
    v_fmac_f32 v74, v237, v18
    v_fmac_f32 v75, v237, v19
    v_fmac_f32 v76, v237, v20
    v_fmac_f32 v77, v237, v21
    v_fmac_f32 v78, v237, v22
    v_fmac_f32 v79, v237, v23
    v_fmac_f32 v80, v238, v16
    v_fmac_f32 v81, v238, v17
    v_fmac_f32 v82, v238, v18
    v_fmac_f32 v83, v238, v19
    v_fmac_f32 v84, v238, v20
    v_fmac_f32 v85, v238, v21
    v_fmac_f32 v86, v238, v22
    v_fmac_f32 v87, v238, v23
    v_fmac_f32 v88, v239, v16
    v_fmac_f32 v89, v239, v17
    v_fmac_f32 v90, v239, v18
    v_fmac_f32 v91, v239, v19
    v_fmac_f32 v92, v239, v20
    v_fmac_f32 v93, v239, v21
    v_fmac_f32 v94, v239, v22
    v_fmac_f32 v95, v239, v23
    ds_read_b128 v[236:239], v1 offset:1664
    s_waitcnt vmcnt(9)
    v_lshlrev_b32 v16, 16, v152
    v_and_b32 v17, 0xffff0000, v152
    v_lshlrev_b32 v18, 16, v153
    v_and_b32 v19, 0xffff0000, v153
    v_lshlrev_b32 v20, 16, v154
    v_and_b32 v21, 0xffff0000, v154
    v_lshlrev_b32 v22, 16, v155
    v_and_b32 v23, 0xffff0000, v155
    s_waitcnt lgkmcnt(0)
    v_fmac_f32 v64, v236, v16
    v_fmac_f32 v65, v236, v17
    v_fmac_f32 v66, v236, v18
    v_fmac_f32 v67, v236, v19
    v_fmac_f32 v68, v236, v20
    v_fmac_f32 v69, v236, v21
    v_fmac_f32 v70, v236, v22
    v_fmac_f32 v71, v236, v23
    v_fmac_f32 v72, v237, v16
    v_fmac_f32 v73, v237, v17
    v_fmac_f32 v74, v237, v18
    v_fmac_f32 v75, v237, v19
    v_fmac_f32 v76, v237, v20
    v_fmac_f32 v77, v237, v21
    v_fmac_f32 v78, v237, v22
    v_fmac_f32 v79, v237, v23
    v_fmac_f32 v80, v238, v16
    v_fmac_f32 v81, v238, v17
    v_fmac_f32 v82, v238, v18
    v_fmac_f32 v83, v238, v19
    v_fmac_f32 v84, v238, v20
    v_fmac_f32 v85, v238, v21
    v_fmac_f32 v86, v238, v22
    v_fmac_f32 v87, v238, v23
    v_fmac_f32 v88, v239, v16
    v_fmac_f32 v89, v239, v17
    v_fmac_f32 v90, v239, v18
    v_fmac_f32 v91, v239, v19
    v_fmac_f32 v92, v239, v20
    v_fmac_f32 v93, v239, v21
    v_fmac_f32 v94, v239, v22
    v_fmac_f32 v95, v239, v23
    ds_read_b128 v[236:239], v1 offset:1728
    s_waitcnt vmcnt(8)
    v_lshlrev_b32 v16, 16, v156
    v_and_b32 v17, 0xffff0000, v156
    v_lshlrev_b32 v18, 16, v157
    v_and_b32 v19, 0xffff0000, v157
    v_lshlrev_b32 v20, 16, v158
    v_and_b32 v21, 0xffff0000, v158
    v_lshlrev_b32 v22, 16, v159
    v_and_b32 v23, 0xffff0000, v159
    s_waitcnt lgkmcnt(0)
    v_fmac_f32 v64, v236, v16
    v_fmac_f32 v65, v236, v17
    v_fmac_f32 v66, v236, v18
    v_fmac_f32 v67, v236, v19
    v_fmac_f32 v68, v236, v20
    v_fmac_f32 v69, v236, v21
    v_fmac_f32 v70, v236, v22
    v_fmac_f32 v71, v236, v23
    v_fmac_f32 v72, v237, v16
    v_fmac_f32 v73, v237, v17
    v_fmac_f32 v74, v237, v18
    v_fmac_f32 v75, v237, v19
    v_fmac_f32 v76, v237, v20
    v_fmac_f32 v77, v237, v21
    v_fmac_f32 v78, v237, v22
    v_fmac_f32 v79, v237, v23
    v_fmac_f32 v80, v238, v16
    v_fmac_f32 v81, v238, v17
    v_fmac_f32 v82, v238, v18
    v_fmac_f32 v83, v238, v19
    v_fmac_f32 v84, v238, v20
    v_fmac_f32 v85, v238, v21
    v_fmac_f32 v86, v238, v22
    v_fmac_f32 v87, v238, v23
    v_fmac_f32 v88, v239, v16
    v_fmac_f32 v89, v239, v17
    v_fmac_f32 v90, v239, v18
    v_fmac_f32 v91, v239, v19
    v_fmac_f32 v92, v239, v20
    v_fmac_f32 v93, v239, v21
    v_fmac_f32 v94, v239, v22
    v_fmac_f32 v95, v239, v23
    ds_read_b128 v[236:239], v1 offset:1792
    s_waitcnt vmcnt(7)
    v_lshlrev_b32 v16, 16, v160
    v_and_b32 v17, 0xffff0000, v160
    v_lshlrev_b32 v18, 16, v161
    v_and_b32 v19, 0xffff0000, v161
    v_lshlrev_b32 v20, 16, v162
    v_and_b32 v21, 0xffff0000, v162
    v_lshlrev_b32 v22, 16, v163
    v_and_b32 v23, 0xffff0000, v163
    s_waitcnt lgkmcnt(0)
    v_fmac_f32 v64, v236, v16
    v_fmac_f32 v65, v236, v17
    v_fmac_f32 v66, v236, v18
    v_fmac_f32 v67, v236, v19
    v_fmac_f32 v68, v236, v20
    v_fmac_f32 v69, v236, v21
    v_fmac_f32 v70, v236, v22
    v_fmac_f32 v71, v236, v23
    v_fmac_f32 v72, v237, v16
    v_fmac_f32 v73, v237, v17
    v_fmac_f32 v74, v237, v18
    v_fmac_f32 v75, v237, v19
    v_fmac_f32 v76, v237, v20
    v_fmac_f32 v77, v237, v21
    v_fmac_f32 v78, v237, v22
    v_fmac_f32 v79, v237, v23
    v_fmac_f32 v80, v238, v16
    v_fmac_f32 v81, v238, v17
    v_fmac_f32 v82, v238, v18
    v_fmac_f32 v83, v238, v19
    v_fmac_f32 v84, v238, v20
    v_fmac_f32 v85, v238, v21
    v_fmac_f32 v86, v238, v22
    v_fmac_f32 v87, v238, v23
    v_fmac_f32 v88, v239, v16
    v_fmac_f32 v89, v239, v17
    v_fmac_f32 v90, v239, v18
    v_fmac_f32 v91, v239, v19
    v_fmac_f32 v92, v239, v20
    v_fmac_f32 v93, v239, v21
    v_fmac_f32 v94, v239, v22
    v_fmac_f32 v95, v239, v23
    ds_read_b128 v[236:239], v1 offset:1856
    s_waitcnt vmcnt(6)
    v_lshlrev_b32 v16, 16, v164
    v_and_b32 v17, 0xffff0000, v164
    v_lshlrev_b32 v18, 16, v165
    v_and_b32 v19, 0xffff0000, v165
    v_lshlrev_b32 v20, 16, v166
    v_and_b32 v21, 0xffff0000, v166
    v_lshlrev_b32 v22, 16, v167
    v_and_b32 v23, 0xffff0000, v167
    s_waitcnt lgkmcnt(0)
    v_fmac_f32 v64, v236, v16
    v_fmac_f32 v65, v236, v17
    v_fmac_f32 v66, v236, v18
    v_fmac_f32 v67, v236, v19
    v_fmac_f32 v68, v236, v20
    v_fmac_f32 v69, v236, v21
    v_fmac_f32 v70, v236, v22
    v_fmac_f32 v71, v236, v23
    v_fmac_f32 v72, v237, v16
    v_fmac_f32 v73, v237, v17
    v_fmac_f32 v74, v237, v18
    v_fmac_f32 v75, v237, v19
    v_fmac_f32 v76, v237, v20
    v_fmac_f32 v77, v237, v21
    v_fmac_f32 v78, v237, v22
    v_fmac_f32 v79, v237, v23
    v_fmac_f32 v80, v238, v16
    v_fmac_f32 v81, v238, v17
    v_fmac_f32 v82, v238, v18
    v_fmac_f32 v83, v238, v19
    v_fmac_f32 v84, v238, v20
    v_fmac_f32 v85, v238, v21
    v_fmac_f32 v86, v238, v22
    v_fmac_f32 v87, v238, v23
    v_fmac_f32 v88, v239, v16
    v_fmac_f32 v89, v239, v17
    v_fmac_f32 v90, v239, v18
    v_fmac_f32 v91, v239, v19
    v_fmac_f32 v92, v239, v20
    v_fmac_f32 v93, v239, v21
    v_fmac_f32 v94, v239, v22
    v_fmac_f32 v95, v239, v23
    ds_read_b128 v[236:239], v1 offset:1920
    s_waitcnt vmcnt(5)
    v_lshlrev_b32 v16, 16, v168
    v_and_b32 v17, 0xffff0000, v168
    v_lshlrev_b32 v18, 16, v169
    v_and_b32 v19, 0xffff0000, v169
    v_lshlrev_b32 v20, 16, v170
    v_and_b32 v21, 0xffff0000, v170
    v_lshlrev_b32 v22, 16, v171
    v_and_b32 v23, 0xffff0000, v171
    s_waitcnt lgkmcnt(0)
    v_fmac_f32 v64, v236, v16
    v_fmac_f32 v65, v236, v17
    v_fmac_f32 v66, v236, v18
    v_fmac_f32 v67, v236, v19
    v_fmac_f32 v68, v236, v20
    v_fmac_f32 v69, v236, v21
    v_fmac_f32 v70, v236, v22
    v_fmac_f32 v71, v236, v23
    v_fmac_f32 v72, v237, v16
    v_fmac_f32 v73, v237, v17
    v_fmac_f32 v74, v237, v18
    v_fmac_f32 v75, v237, v19
    v_fmac_f32 v76, v237, v20
    v_fmac_f32 v77, v237, v21
    v_fmac_f32 v78, v237, v22
    v_fmac_f32 v79, v237, v23
    v_fmac_f32 v80, v238, v16
    v_fmac_f32 v81, v238, v17
    v_fmac_f32 v82, v238, v18
    v_fmac_f32 v83, v238, v19
    v_fmac_f32 v84, v238, v20
    v_fmac_f32 v85, v238, v21
    v_fmac_f32 v86, v238, v22
    v_fmac_f32 v87, v238, v23
    v_fmac_f32 v88, v239, v16
    v_fmac_f32 v89, v239, v17
    v_fmac_f32 v90, v239, v18
    v_fmac_f32 v91, v239, v19
    v_fmac_f32 v92, v239, v20
    v_fmac_f32 v93, v239, v21
    v_fmac_f32 v94, v239, v22
    v_fmac_f32 v95, v239, v23
    ds_read_b128 v[236:239], v1 offset:1984
    s_waitcnt vmcnt(4)
    v_lshlrev_b32 v16, 16, v172
    v_and_b32 v17, 0xffff0000, v172
    v_lshlrev_b32 v18, 16, v173
    v_and_b32 v19, 0xffff0000, v173
    v_lshlrev_b32 v20, 16, v174
    v_and_b32 v21, 0xffff0000, v174
    v_lshlrev_b32 v22, 16, v175
    v_and_b32 v23, 0xffff0000, v175
    s_waitcnt lgkmcnt(0)
    v_fmac_f32 v64, v236, v16
    v_fmac_f32 v65, v236, v17
    v_fmac_f32 v66, v236, v18
    v_fmac_f32 v67, v236, v19
    v_fmac_f32 v68, v236, v20
    v_fmac_f32 v69, v236, v21
    v_fmac_f32 v70, v236, v22
    v_fmac_f32 v71, v236, v23
    v_fmac_f32 v72, v237, v16
    v_fmac_f32 v73, v237, v17
    v_fmac_f32 v74, v237, v18
    v_fmac_f32 v75, v237, v19
    v_fmac_f32 v76, v237, v20
    v_fmac_f32 v77, v237, v21
    v_fmac_f32 v78, v237, v22
    v_fmac_f32 v79, v237, v23
    v_fmac_f32 v80, v238, v16
    v_fmac_f32 v81, v238, v17
    v_fmac_f32 v82, v238, v18
    v_fmac_f32 v83, v238, v19
    v_fmac_f32 v84, v238, v20
    v_fmac_f32 v85, v238, v21
    v_fmac_f32 v86, v238, v22
    v_fmac_f32 v87, v238, v23
    v_fmac_f32 v88, v239, v16
    v_fmac_f32 v89, v239, v17
    v_fmac_f32 v90, v239, v18
    v_fmac_f32 v91, v239, v19
    v_fmac_f32 v92, v239, v20
    v_fmac_f32 v93, v239, v21
    v_fmac_f32 v94, v239, v22
    v_fmac_f32 v95, v239, v23
    v_lshl_add_u32 v1, v8, 2, v11
    v_lshlrev_b32 v1, 11, v1
    v_lshl_add_u32 v1, v10, 5, v1
    ds_write_b128 v1, v[64:67] offset:8192
    ds_write_b128 v1, v[68:71] offset:8208
    ds_write_b128 v1, v[72:75] offset:8704
    ds_write_b128 v1, v[76:79] offset:8720
    ds_write_b128 v1, v[80:83] offset:9216
    ds_write_b128 v1, v[84:87] offset:9232
    ds_write_b128 v1, v[88:91] offset:9728
    ds_write_b128 v1, v[92:95] offset:9744
    s_waitcnt lgkmcnt(0)
    s_barrier
    v_lshlrev_b32 v1, 3, v0
    ds_read_b64 v[16:17], v1 offset:8192
    ds_read_b64 v[18:19], v1 offset:10240
    ds_read_b64 v[20:21], v1 offset:12288
    ds_read_b64 v[22:23], v1 offset:14336
    ds_read_b64 v[24:25], v1 offset:16384
    ds_read_b64 v[26:27], v1 offset:18432
    ds_read_b64 v[28:29], v1 offset:20480
    ds_read_b64 v[30:31], v1 offset:22528
    ds_read_b64 v[32:33], v1 offset:24576
    ds_read_b64 v[34:35], v1 offset:26624
    ds_read_b64 v[36:37], v1 offset:28672
    ds_read_b64 v[38:39], v1 offset:30720
    ds_read_b64 v[40:41], v1 offset:32768
    ds_read_b64 v[42:43], v1 offset:34816
    ds_read_b64 v[44:45], v1 offset:36864
    ds_read_b64 v[46:47], v1 offset:38912
    s_waitcnt lgkmcnt(0)
    v_add_f32 v16, v16, v18
    v_add_f32 v17, v17, v19
    v_add_f32 v16, v16, v20
    v_add_f32 v17, v17, v21
    v_add_f32 v16, v16, v22
    v_add_f32 v17, v17, v23
    v_add_f32 v16, v16, v24
    v_add_f32 v17, v17, v25
    v_add_f32 v16, v16, v26
    v_add_f32 v17, v17, v27
    v_add_f32 v16, v16, v28
    v_add_f32 v17, v17, v29
    v_add_f32 v16, v16, v30
    v_add_f32 v17, v17, v31
    v_add_f32 v16, v16, v32
    v_add_f32 v17, v17, v33
    v_add_f32 v16, v16, v34
    v_add_f32 v17, v17, v35
    v_add_f32 v16, v16, v36
    v_add_f32 v17, v17, v37
    v_add_f32 v16, v16, v38
    v_add_f32 v17, v17, v39
    v_add_f32 v16, v16, v40
    v_add_f32 v17, v17, v41
    v_add_f32 v16, v16, v42
    v_add_f32 v17, v17, v43
    v_add_f32 v16, v16, v44
    v_add_f32 v17, v17, v45
    v_add_f32 v16, v16, v46
    v_add_f32 v17, v17, v47
    v_mov_b32 v20, v16
    v_mov_b32 v21, s80
    v_mov_b32 v22, v17
    v_mov_b32 v23, s80
    v_lshlrev_b32 v2, 14, v8
    v_lshl_add_u32 v2, v9, 4, v2
    s_lshl_b32 s52, s54, 16
    s_lshl_b32 s53, s55, 10
    s_add_u32 s52, s52, s53
    s_add_u32 s52, s52, 65536
    buffer_store_dwordx4 v[20:23], v2, s[44:47], s52 offen sc0 sc1
    v_cmp_gt_u32 vcc, 4, v0
    s_and_saveexec_b64 s[82:83], vcc
    v_lshlrev_b32 v2, 2, v0
    ds_read_b32 v24, v2 offset:5184
    ds_read_b32 v25, v2 offset:5200
    ds_read_b32 v26, v2 offset:5216
    ds_read_b32 v27, v2 offset:5232
    s_waitcnt lgkmcnt(0)
    v_add_f32 v24, v24, v25
    v_add_f32 v26, v26, v27
    v_add_f32 v29, v24, v26
    v_mov_b32 v28, v48
    v_cmp_eq_u32 vcc, 1, v0
    s_nop 1
    v_cndmask_b32 v28, v28, v49, vcc
    v_cmp_eq_u32 vcc, 2, v0
    s_nop 1
    v_cndmask_b32 v28, v28, v50, vcc
    v_cmp_eq_u32 vcc, 3, v0
    s_nop 1
    v_cndmask_b32 v28, v28, v51, vcc
    v_mov_b32 v30, s80
    v_mov_b32 v31, s80
    v_lshlrev_b32 v2, 8, v0
    s_lshl_b32 s52, s54, 10
    s_lshl_b32 s53, s55, 4
    s_add_u32 s52, s52, s53
    s_add_u32 s52, s52, 1114112
    buffer_store_dwordx4 v[28:31], v2, s[44:47], s52 offen sc0 sc1
    s_mov_b64 exec, s[82:83]
    v_lshrrev_b32 v6, 7, v0
    v_and_b32 v7, 127, v0
    v_lshlrev_b32 v1, 19, v6
    v_lshl_add_u32 v1, v7, 3, v1
    s_lshl_b32 s52, s58, 14
    s_add_u32 s52, s52, 65536
    s_add_u32 s53, s52, 4096
    s_add_u32 s94, s52, 8192
    s_add_u32 s95, s52, 12288
    v_lshlrev_b32 v2, 13, v6
    s_lshl_b32 s96, s58, 8
    s_add_u32 s96, s96, 1114112
    s_mov_b32 s81, 100000
Lpoll2:
    buffer_load_dwordx2 v[48:49], v1, s[44:47], s52 offen offset:0 sc0 sc1
    buffer_load_dwordx2 v[50:51], v1, s[44:47], s52 offen offset:1024 sc0 sc1
    buffer_load_dwordx2 v[52:53], v1, s[44:47], s52 offen offset:2048 sc0 sc1
    buffer_load_dwordx2 v[54:55], v1, s[44:47], s52 offen offset:3072 sc0 sc1
    buffer_load_dwordx2 v[56:57], v1, s[44:47], s53 offen offset:0 sc0 sc1
    buffer_load_dwordx2 v[58:59], v1, s[44:47], s53 offen offset:1024 sc0 sc1
    buffer_load_dwordx2 v[60:61], v1, s[44:47], s53 offen offset:2048 sc0 sc1
    buffer_load_dwordx2 v[62:63], v1, s[44:47], s53 offen offset:3072 sc0 sc1
    buffer_load_dwordx2 v[64:65], v1, s[44:47], s94 offen offset:0 sc0 sc1
    buffer_load_dwordx2 v[66:67], v1, s[44:47], s94 offen offset:1024 sc0 sc1
    buffer_load_dwordx2 v[68:69], v1, s[44:47], s94 offen offset:2048 sc0 sc1
    buffer_load_dwordx2 v[70:71], v1, s[44:47], s94 offen offset:3072 sc0 sc1
    buffer_load_dwordx2 v[72:73], v1, s[44:47], s95 offen offset:0 sc0 sc1
    buffer_load_dwordx2 v[74:75], v1, s[44:47], s95 offen offset:1024 sc0 sc1
    buffer_load_dwordx2 v[76:77], v1, s[44:47], s95 offen offset:2048 sc0 sc1
    buffer_load_dwordx2 v[78:79], v1, s[44:47], s95 offen offset:3072 sc0 sc1
    buffer_load_dwordx4 v[80:83], v2, s[44:47], s96 offen offset:0 sc0 sc1
    buffer_load_dwordx4 v[84:87], v2, s[44:47], s96 offen offset:16 sc0 sc1
    buffer_load_dwordx4 v[88:91], v2, s[44:47], s96 offen offset:32 sc0 sc1
    buffer_load_dwordx4 v[92:95], v2, s[44:47], s96 offen offset:48 sc0 sc1
    buffer_load_dwordx4 v[96:99], v2, s[44:47], s96 offen offset:64 sc0 sc1
    buffer_load_dwordx4 v[100:103], v2, s[44:47], s96 offen offset:80 sc0 sc1
    buffer_load_dwordx4 v[104:107], v2, s[44:47], s96 offen offset:96 sc0 sc1
    buffer_load_dwordx4 v[108:111], v2, s[44:47], s96 offen offset:112 sc0 sc1
    buffer_load_dwordx4 v[112:115], v2, s[44:47], s96 offen offset:128 sc0 sc1
    buffer_load_dwordx4 v[116:119], v2, s[44:47], s96 offen offset:144 sc0 sc1
    buffer_load_dwordx4 v[120:123], v2, s[44:47], s96 offen offset:160 sc0 sc1
    buffer_load_dwordx4 v[124:127], v2, s[44:47], s96 offen offset:176 sc0 sc1
    buffer_load_dwordx4 v[128:131], v2, s[44:47], s96 offen offset:192 sc0 sc1
    buffer_load_dwordx4 v[132:135], v2, s[44:47], s96 offen offset:208 sc0 sc1
    buffer_load_dwordx4 v[136:139], v2, s[44:47], s96 offen offset:224 sc0 sc1
    buffer_load_dwordx4 v[140:143], v2, s[44:47], s96 offen offset:240 sc0 sc1
    s_waitcnt vmcnt(0)
    v_cmp_ne_u32 vcc, s80, v49
    v_cmp_ne_u32 s[82:83], s80, v51
    s_or_b64 vcc, vcc, s[82:83]
    v_cmp_ne_u32 s[82:83], s80, v53
    s_or_b64 vcc, vcc, s[82:83]
    v_cmp_ne_u32 s[82:83], s80, v55
    s_or_b64 vcc, vcc, s[82:83]
    v_cmp_ne_u32 s[82:83], s80, v57
    s_or_b64 vcc, vcc, s[82:83]
    v_cmp_ne_u32 s[82:83], s80, v59
    s_or_b64 vcc, vcc, s[82:83]
    v_cmp_ne_u32 s[82:83], s80, v61
    s_or_b64 vcc, vcc, s[82:83]
    v_cmp_ne_u32 s[82:83], s80, v63
    s_or_b64 vcc, vcc, s[82:83]
    v_cmp_ne_u32 s[82:83], s80, v65
    s_or_b64 vcc, vcc, s[82:83]
    v_cmp_ne_u32 s[82:83], s80, v67
    s_or_b64 vcc, vcc, s[82:83]
    v_cmp_ne_u32 s[82:83], s80, v69
    s_or_b64 vcc, vcc, s[82:83]
    v_cmp_ne_u32 s[82:83], s80, v71
    s_or_b64 vcc, vcc, s[82:83]
    v_cmp_ne_u32 s[82:83], s80, v73
    s_or_b64 vcc, vcc, s[82:83]
    v_cmp_ne_u32 s[82:83], s80, v75
    s_or_b64 vcc, vcc, s[82:83]
    v_cmp_ne_u32 s[82:83], s80, v77
    s_or_b64 vcc, vcc, s[82:83]
    v_cmp_ne_u32 s[82:83], s80, v79
    s_or_b64 vcc, vcc, s[82:83]
    v_cmp_ne_u32 s[82:83], s80, v82
    s_or_b64 vcc, vcc, s[82:83]
    v_cmp_ne_u32 s[82:83], s80, v86
    s_or_b64 vcc, vcc, s[82:83]
    v_cmp_ne_u32 s[82:83], s80, v90
    s_or_b64 vcc, vcc, s[82:83]
    v_cmp_ne_u32 s[82:83], s80, v94
    s_or_b64 vcc, vcc, s[82:83]
    v_cmp_ne_u32 s[82:83], s80, v98
    s_or_b64 vcc, vcc, s[82:83]
    v_cmp_ne_u32 s[82:83], s80, v102
    s_or_b64 vcc, vcc, s[82:83]
    v_cmp_ne_u32 s[82:83], s80, v106
    s_or_b64 vcc, vcc, s[82:83]
    v_cmp_ne_u32 s[82:83], s80, v110
    s_or_b64 vcc, vcc, s[82:83]
    v_cmp_ne_u32 s[82:83], s80, v114
    s_or_b64 vcc, vcc, s[82:83]
    v_cmp_ne_u32 s[82:83], s80, v118
    s_or_b64 vcc, vcc, s[82:83]
    v_cmp_ne_u32 s[82:83], s80, v122
    s_or_b64 vcc, vcc, s[82:83]
    v_cmp_ne_u32 s[82:83], s80, v126
    s_or_b64 vcc, vcc, s[82:83]
    v_cmp_ne_u32 s[82:83], s80, v130
    s_or_b64 vcc, vcc, s[82:83]
    v_cmp_ne_u32 s[82:83], s80, v134
    s_or_b64 vcc, vcc, s[82:83]
    v_cmp_ne_u32 s[82:83], s80, v138
    s_or_b64 vcc, vcc, s[82:83]
    v_cmp_ne_u32 s[82:83], s80, v142
    s_or_b64 vcc, vcc, s[82:83]
    s_cbranch_vccz Lpoll2_ok
    s_sleep 1
    s_sub_u32 s81, s81, 1
    s_cmp_eq_u32 s81, 0
    s_cbranch_scc0 Lpoll2
Lpoll2_ok:
    v_max_f32 v3, v80, v84
    v_max_f32 v3, v3, v88
    v_max_f32 v3, v3, v92
    v_max_f32 v3, v3, v96
    v_max_f32 v3, v3, v100
    v_max_f32 v3, v3, v104
    v_max_f32 v3, v3, v108
    v_max_f32 v3, v3, v112
    v_max_f32 v3, v3, v116
    v_max_f32 v3, v3, v120
    v_max_f32 v3, v3, v124
    v_max_f32 v3, v3, v128
    v_max_f32 v3, v3, v132
    v_max_f32 v3, v3, v136
    v_max_f32 v3, v3, v140
    v_mov_b32 v4, 0
    v_mov_b32 v5, 0
    v_sub_f32 v80, v80, v3
    v_exp_f32 v80, v80
    s_nop 0
    v_fmac_f32 v4, v80, v81
    v_fmac_f32 v5, v80, v48
    v_sub_f32 v84, v84, v3
    v_exp_f32 v84, v84
    s_nop 0
    v_fmac_f32 v4, v84, v85
    v_fmac_f32 v5, v84, v50
    v_sub_f32 v88, v88, v3
    v_exp_f32 v88, v88
    s_nop 0
    v_fmac_f32 v4, v88, v89
    v_fmac_f32 v5, v88, v52
    v_sub_f32 v92, v92, v3
    v_exp_f32 v92, v92
    s_nop 0
    v_fmac_f32 v4, v92, v93
    v_fmac_f32 v5, v92, v54
    v_sub_f32 v96, v96, v3
    v_exp_f32 v96, v96
    s_nop 0
    v_fmac_f32 v4, v96, v97
    v_fmac_f32 v5, v96, v56
    v_sub_f32 v100, v100, v3
    v_exp_f32 v100, v100
    s_nop 0
    v_fmac_f32 v4, v100, v101
    v_fmac_f32 v5, v100, v58
    v_sub_f32 v104, v104, v3
    v_exp_f32 v104, v104
    s_nop 0
    v_fmac_f32 v4, v104, v105
    v_fmac_f32 v5, v104, v60
    v_sub_f32 v108, v108, v3
    v_exp_f32 v108, v108
    s_nop 0
    v_fmac_f32 v4, v108, v109
    v_fmac_f32 v5, v108, v62
    v_sub_f32 v112, v112, v3
    v_exp_f32 v112, v112
    s_nop 0
    v_fmac_f32 v4, v112, v113
    v_fmac_f32 v5, v112, v64
    v_sub_f32 v116, v116, v3
    v_exp_f32 v116, v116
    s_nop 0
    v_fmac_f32 v4, v116, v117
    v_fmac_f32 v5, v116, v66
    v_sub_f32 v120, v120, v3
    v_exp_f32 v120, v120
    s_nop 0
    v_fmac_f32 v4, v120, v121
    v_fmac_f32 v5, v120, v68
    v_sub_f32 v124, v124, v3
    v_exp_f32 v124, v124
    s_nop 0
    v_fmac_f32 v4, v124, v125
    v_fmac_f32 v5, v124, v70
    v_sub_f32 v128, v128, v3
    v_exp_f32 v128, v128
    s_nop 0
    v_fmac_f32 v4, v128, v129
    v_fmac_f32 v5, v128, v72
    v_sub_f32 v132, v132, v3
    v_exp_f32 v132, v132
    s_nop 0
    v_fmac_f32 v4, v132, v133
    v_fmac_f32 v5, v132, v74
    v_sub_f32 v136, v136, v3
    v_exp_f32 v136, v136
    s_nop 0
    v_fmac_f32 v4, v136, v137
    v_fmac_f32 v5, v136, v76
    v_sub_f32 v140, v140, v3
    v_exp_f32 v140, v140
    s_nop 0
    v_fmac_f32 v4, v140, v141
    v_fmac_f32 v5, v140, v78
    v_rcp_f32 v4, v4
    s_nop 0
    v_mul_f32 v5, v5, v4
    v_cvt_pk_bf16_f32 v3, v5, v5
    v_lshlrev_b32 v5, 16, v3
    s_barrier
    v_lshlrev_b32 v3, 2, v0
    ds_write_b32 v3, v5 offset:16384
    s_waitcnt lgkmcnt(0)
    s_barrier
    v_mov_b32 v236, 0
    v_mov_b32 v237, 0
    v_mov_b32 v238, 0
    v_mov_b32 v239, 0
    v_mov_b32 v240, 0
    v_mov_b32 v241, 0
    v_mov_b32 v242, 0
    v_mov_b32 v243, 0
    v_mov_b32 v244, 0
    v_mov_b32 v245, 0
    v_mov_b32 v246, 0
    v_mov_b32 v247, 0
    v_mov_b32 v248, 0
    v_mov_b32 v249, 0
    v_mov_b32 v250, 0
    v_mov_b32 v251, 0
    v_lshrrev_b32 v5, 3, v0
    v_lshlrev_b32 v5, 2, v5
    ds_read_b32 v24, v5 offset:16384
    ds_read_b32 v25, v5 offset:16896
    ds_read_b32 v26, v5 offset:16512
    ds_read_b32 v27, v5 offset:17024
    ds_read_b32 v28, v5 offset:16640
    ds_read_b32 v29, v5 offset:17152
    ds_read_b32 v30, v5 offset:16768
    ds_read_b32 v31, v5 offset:17280
    s_waitcnt lgkmcnt(0)
    v_lshlrev_b32 v16, 16, v176
    v_and_b32 v17, 0xffff0000, v176
    v_lshlrev_b32 v18, 16, v177
    v_and_b32 v19, 0xffff0000, v177
    v_lshlrev_b32 v20, 16, v178
    v_and_b32 v21, 0xffff0000, v178
    v_lshlrev_b32 v22, 16, v179
    v_and_b32 v23, 0xffff0000, v179
    v_fmac_f32 v236, v24, v16
    v_fmac_f32 v244, v25, v16
    v_fmac_f32 v237, v24, v17
    v_fmac_f32 v245, v25, v17
    v_fmac_f32 v238, v24, v18
    v_fmac_f32 v246, v25, v18
    v_fmac_f32 v239, v24, v19
    v_fmac_f32 v247, v25, v19
    v_fmac_f32 v240, v24, v20
    v_fmac_f32 v248, v25, v20
    v_fmac_f32 v241, v24, v21
    v_fmac_f32 v249, v25, v21
    v_fmac_f32 v242, v24, v22
    v_fmac_f32 v250, v25, v22
    v_fmac_f32 v243, v24, v23
    v_fmac_f32 v251, v25, v23
    v_lshlrev_b32 v16, 16, v180
    v_and_b32 v17, 0xffff0000, v180
    v_lshlrev_b32 v18, 16, v181
    v_and_b32 v19, 0xffff0000, v181
    v_lshlrev_b32 v20, 16, v182
    v_and_b32 v21, 0xffff0000, v182
    v_lshlrev_b32 v22, 16, v183
    v_and_b32 v23, 0xffff0000, v183
    v_fmac_f32 v236, v26, v16
    v_fmac_f32 v244, v27, v16
    v_fmac_f32 v237, v26, v17
    v_fmac_f32 v245, v27, v17
    v_fmac_f32 v238, v26, v18
    v_fmac_f32 v246, v27, v18
    v_fmac_f32 v239, v26, v19
    v_fmac_f32 v247, v27, v19
    v_fmac_f32 v240, v26, v20
    v_fmac_f32 v248, v27, v20
    v_fmac_f32 v241, v26, v21
    v_fmac_f32 v249, v27, v21
    v_fmac_f32 v242, v26, v22
    v_fmac_f32 v250, v27, v22
    v_fmac_f32 v243, v26, v23
    v_fmac_f32 v251, v27, v23
    v_lshlrev_b32 v16, 16, v184
    v_and_b32 v17, 0xffff0000, v184
    v_lshlrev_b32 v18, 16, v185
    v_and_b32 v19, 0xffff0000, v185
    v_lshlrev_b32 v20, 16, v186
    v_and_b32 v21, 0xffff0000, v186
    v_lshlrev_b32 v22, 16, v187
    v_and_b32 v23, 0xffff0000, v187
    v_fmac_f32 v236, v28, v16
    v_fmac_f32 v244, v29, v16
    v_fmac_f32 v237, v28, v17
    v_fmac_f32 v245, v29, v17
    v_fmac_f32 v238, v28, v18
    v_fmac_f32 v246, v29, v18
    v_fmac_f32 v239, v28, v19
    v_fmac_f32 v247, v29, v19
    v_fmac_f32 v240, v28, v20
    v_fmac_f32 v248, v29, v20
    v_fmac_f32 v241, v28, v21
    v_fmac_f32 v249, v29, v21
    v_fmac_f32 v242, v28, v22
    v_fmac_f32 v250, v29, v22
    v_fmac_f32 v243, v28, v23
    v_fmac_f32 v251, v29, v23
    v_lshlrev_b32 v16, 16, v188
    v_and_b32 v17, 0xffff0000, v188
    v_lshlrev_b32 v18, 16, v189
    v_and_b32 v19, 0xffff0000, v189
    v_lshlrev_b32 v20, 16, v190
    v_and_b32 v21, 0xffff0000, v190
    v_lshlrev_b32 v22, 16, v191
    v_and_b32 v23, 0xffff0000, v191
    v_fmac_f32 v236, v30, v16
    v_fmac_f32 v244, v31, v16
    v_fmac_f32 v237, v30, v17
    v_fmac_f32 v245, v31, v17
    v_fmac_f32 v238, v30, v18
    v_fmac_f32 v246, v31, v18
    v_fmac_f32 v239, v30, v19
    v_fmac_f32 v247, v31, v19
    v_fmac_f32 v240, v30, v20
    v_fmac_f32 v248, v31, v20
    v_fmac_f32 v241, v30, v21
    v_fmac_f32 v249, v31, v21
    v_fmac_f32 v242, v30, v22
    v_fmac_f32 v250, v31, v22
    v_fmac_f32 v243, v30, v23
    v_fmac_f32 v251, v31, v23
    v_lshlrev_b32 v1, 6, v0
    ds_write_b128 v1, v[236:239] offset:0
    ds_write_b128 v1, v[240:243] offset:16
    ds_write_b128 v1, v[244:247] offset:32
    ds_write_b128 v1, v[248:251] offset:48
    s_waitcnt lgkmcnt(0)
    s_barrier
    v_cmp_gt_u32 vcc, 128, v0
    s_and_saveexec_b64 s[82:83], vcc
    v_and_b32 v1, 63, v0
    v_lshrrev_b32 v2, 3, v1
    v_lshlrev_b32 v2, 6, v2
    v_and_b32 v3, 7, v1
    v_lshrrev_b32 v4, 6, v0
    v_lshl_add_u32 v3, v4, 3, v3
    v_lshl_add_u32 v2, v3, 2, v2
    ds_read_b32 v16, v2 offset:0
    ds_read_b32 v17, v2 offset:512
    ds_read_b32 v18, v2 offset:1024
    ds_read_b32 v19, v2 offset:1536
    ds_read_b32 v20, v2 offset:2048
    ds_read_b32 v21, v2 offset:2560
    ds_read_b32 v22, v2 offset:3072
    ds_read_b32 v23, v2 offset:3584
    ds_read_b32 v24, v2 offset:4096
    ds_read_b32 v25, v2 offset:4608
    ds_read_b32 v26, v2 offset:5120
    ds_read_b32 v27, v2 offset:5632
    ds_read_b32 v28, v2 offset:6144
    ds_read_b32 v29, v2 offset:6656
    ds_read_b32 v30, v2 offset:7168
    ds_read_b32 v31, v2 offset:7680
    ds_read_b32 v32, v2 offset:8192
    ds_read_b32 v33, v2 offset:8704
    ds_read_b32 v34, v2 offset:9216
    ds_read_b32 v35, v2 offset:9728
    ds_read_b32 v36, v2 offset:10240
    ds_read_b32 v37, v2 offset:10752
    ds_read_b32 v38, v2 offset:11264
    ds_read_b32 v39, v2 offset:11776
    ds_read_b32 v40, v2 offset:12288
    ds_read_b32 v41, v2 offset:12800
    ds_read_b32 v42, v2 offset:13312
    ds_read_b32 v43, v2 offset:13824
    ds_read_b32 v44, v2 offset:14336
    ds_read_b32 v45, v2 offset:14848
    ds_read_b32 v46, v2 offset:15360
    ds_read_b32 v47, v2 offset:15872
    s_waitcnt lgkmcnt(0)
    v_add_f32 v16, v16, v17
    v_add_f32 v16, v16, v18
    v_add_f32 v16, v16, v19
    v_add_f32 v16, v16, v20
    v_add_f32 v16, v16, v21
    v_add_f32 v16, v16, v22
    v_add_f32 v16, v16, v23
    v_add_f32 v16, v16, v24
    v_add_f32 v16, v16, v25
    v_add_f32 v16, v16, v26
    v_add_f32 v16, v16, v27
    v_add_f32 v16, v16, v28
    v_add_f32 v16, v16, v29
    v_add_f32 v16, v16, v30
    v_add_f32 v16, v16, v31
    v_add_f32 v16, v16, v32
    v_add_f32 v16, v16, v33
    v_add_f32 v16, v16, v34
    v_add_f32 v16, v16, v35
    v_add_f32 v16, v16, v36
    v_add_f32 v16, v16, v37
    v_add_f32 v16, v16, v38
    v_add_f32 v16, v16, v39
    v_add_f32 v16, v16, v40
    v_add_f32 v16, v16, v41
    v_add_f32 v16, v16, v42
    v_add_f32 v16, v16, v43
    v_add_f32 v16, v16, v44
    v_add_f32 v16, v16, v45
    v_add_f32 v16, v16, v46
    v_add_f32 v16, v16, v47
    v_mov_b32 v17, s80
    v_lshrrev_b32 v2, 2, v0
    v_lshlrev_b32 v2, 10, v2
    v_and_b32 v3, 3, v0
    v_lshl_add_u32 v2, v3, 3, v2
    s_lshl_b32 s52, s59, 15
    s_lshl_b32 s53, s58, 5
    s_add_u32 s52, s52, s53
    s_add_u32 s52, s52, 1179648
    buffer_store_dwordx2 v[16:17], v2, s[44:47], s52 offen sc0 sc1
    v_lshlrev_b32 v2, 3, v0
    s_lshl_b32 s52, s59, 15
    s_lshl_b32 s53, s58, 10
    s_add_u32 s52, s52, s53
    s_add_u32 s52, s52, 1179648
    s_mov_b32 s81, 100000
Lpoll3:
    buffer_load_dwordx2 v[16:17], v2, s[44:47], s52 offen sc0 sc1
    s_waitcnt vmcnt(0)
    v_cmp_ne_u32 vcc, s80, v17
    s_cbranch_vccz Lpoll3_ok
    s_sleep 1
    s_sub_u32 s81, s81, 1
    s_cmp_eq_u32 s81, 0
    s_cbranch_scc0 Lpoll3
Lpoll3_ok:
    v_lshlrev_b32 v2, 2, v0
    ds_write_b32 v2, v16 offset:20480
    s_mov_b64 exec, s[82:83]
    s_waitcnt lgkmcnt(0)
    s_barrier
    v_cmp_gt_u32 vcc, 4, v0
    s_and_saveexec_b64 s[82:83], vcc
    v_lshlrev_b32 v2, 2, v0
    ds_read_b32 v16, v2 offset:20480
    ds_read_b32 v17, v2 offset:20496
    ds_read_b32 v18, v2 offset:20512
    ds_read_b32 v19, v2 offset:20528
    ds_read_b32 v20, v2 offset:20544
    ds_read_b32 v21, v2 offset:20560
    ds_read_b32 v22, v2 offset:20576
    ds_read_b32 v23, v2 offset:20592
    ds_read_b32 v24, v2 offset:20608
    ds_read_b32 v25, v2 offset:20624
    ds_read_b32 v26, v2 offset:20640
    ds_read_b32 v27, v2 offset:20656
    ds_read_b32 v28, v2 offset:20672
    ds_read_b32 v29, v2 offset:20688
    ds_read_b32 v30, v2 offset:20704
    ds_read_b32 v31, v2 offset:20720
    ds_read_b32 v32, v2 offset:20736
    ds_read_b32 v33, v2 offset:20752
    ds_read_b32 v34, v2 offset:20768
    ds_read_b32 v35, v2 offset:20784
    ds_read_b32 v36, v2 offset:20800
    ds_read_b32 v37, v2 offset:20816
    ds_read_b32 v38, v2 offset:20832
    ds_read_b32 v39, v2 offset:20848
    ds_read_b32 v40, v2 offset:20864
    ds_read_b32 v41, v2 offset:20880
    ds_read_b32 v42, v2 offset:20896
    ds_read_b32 v43, v2 offset:20912
    ds_read_b32 v44, v2 offset:20928
    ds_read_b32 v45, v2 offset:20944
    ds_read_b32 v46, v2 offset:20960
    ds_read_b32 v47, v2 offset:20976
    s_lshl_b32 s52, s58, 2
    s_lshr_b32 s53, s52, 6
    s_and_b32 s52, s52, 63
    s_lshl_b32 s53, s53, 9
    s_add_u32 s52, s52, s53
    s_lshl_b32 s53, s59, 6
    s_add_u32 s52, s52, s53
    v_add_u32 v3, s52, v0
    v_lshlrev_b32 v4, 1, v3
    buffer_load_ushort v5, v4, s[8:11], 0 offen
    s_waitcnt lgkmcnt(0)
    v_add_f32 v16, v16, v17
    v_add_f32 v16, v16, v18
    v_add_f32 v16, v16, v19
    v_add_f32 v16, v16, v20
    v_add_f32 v16, v16, v21
    v_add_f32 v16, v16, v22
    v_add_f32 v16, v16, v23
    v_add_f32 v16, v16, v24
    v_add_f32 v16, v16, v25
    v_add_f32 v16, v16, v26
    v_add_f32 v16, v16, v27
    v_add_f32 v16, v16, v28
    v_add_f32 v16, v16, v29
    v_add_f32 v16, v16, v30
    v_add_f32 v16, v16, v31
    v_add_f32 v16, v16, v32
    v_add_f32 v16, v16, v33
    v_add_f32 v16, v16, v34
    v_add_f32 v16, v16, v35
    v_add_f32 v16, v16, v36
    v_add_f32 v16, v16, v37
    v_add_f32 v16, v16, v38
    v_add_f32 v16, v16, v39
    v_add_f32 v16, v16, v40
    v_add_f32 v16, v16, v41
    v_add_f32 v16, v16, v42
    v_add_f32 v16, v16, v43
    v_add_f32 v16, v16, v44
    v_add_f32 v16, v16, v45
    v_add_f32 v16, v16, v46
    v_add_f32 v16, v16, v47
    v_cvt_pk_bf16_f32 v6, v16, v16
    v_lshlrev_b32 v16, 16, v6
    s_waitcnt vmcnt(0)
    v_lshlrev_b32 v5, 16, v5
    v_add_f32 v16, v16, v5
    v_cvt_pk_bf16_f32 v6, v16, v16
    v_lshlrev_b32 v16, 16, v6
    v_mov_b32 v17, s80
    v_lshlrev_b32 v4, 3, v3
    s_mov_b32 s52, 1441792
    buffer_store_dwordx2 v[16:17], v4, s[44:47], s52 offen sc0 sc1
    s_mov_b64 exec, s[82:83]
    v_lshlrev_b32 v2, 5, v0
    s_mov_b32 s52, 1441792
    s_mov_b32 s81, 100000
Lpoll4:
    buffer_load_dwordx4 v[16:19], v2, s[44:47], s52 offen sc0 sc1
    buffer_load_dwordx4 v[20:23], v2, s[44:47], s52 offen offset:16 sc0 sc1
    s_waitcnt vmcnt(0)
    v_cmp_ne_u32 vcc, s80, v17
    v_cmp_ne_u32 s[82:83], s80, v19
    s_or_b64 vcc, vcc, s[82:83]
    v_cmp_ne_u32 s[82:83], s80, v21
    s_or_b64 vcc, vcc, s[82:83]
    v_cmp_ne_u32 s[82:83], s80, v23
    s_or_b64 vcc, vcc, s[82:83]
    s_cbranch_vccz Lpoll4_ok
    s_sleep 1
    s_sub_u32 s81, s81, 1
    s_cmp_eq_u32 s81, 0
    s_cbranch_scc0 Lpoll4
Lpoll4_ok:
    v_mov_b32 v48, v16
    v_mov_b32 v49, v18
    v_mov_b32 v50, v20
    v_mov_b32 v51, v22
    v_lshlrev_b32 v1, 4, v0
    ds_write_b128 v1, v[48:51] offset:24576
    s_cmp_ge_u32 s6, 224
    s_cbranch_scc1 L_skipD
    v_add_f32 v20, v48, v49
    v_add_f32 v21, v50, v51
    v_add_f32 v20, v20, v21
    s_nop 1
    v_add_f32_dpp v20, v20, v20 row_ror:8 row_mask:0xf bank_mask:0xf
    s_nop 1
    v_add_f32_dpp v20, v20, v20 row_ror:4 row_mask:0xf bank_mask:0xf
    s_nop 1
    v_add_f32_dpp v20, v20, v20 row_ror:2 row_mask:0xf bank_mask:0xf
    s_nop 1
    v_add_f32_dpp v20, v20, v20 row_ror:1 row_mask:0xf bank_mask:0xf
    s_nop 1
    v_readlane_b32 s60, v20, 0
    v_readlane_b32 s61, v20, 16
    v_readlane_b32 s62, v20, 32
    v_readlane_b32 s63, v20, 48
    s_nop 1
    v_mov_b32 v20, s60
    v_add_f32 v20, s61, v20
    v_add_f32 v20, s62, v20
    v_add_f32 v20, s63, v20
    v_lshrrev_b32 v21, 6, v0
    v_lshlrev_b32 v21, 2, v21
    ds_write_b32 v21, v20 offset:20992
    s_waitcnt lgkmcnt(0)
    s_barrier
    v_lshrrev_b32 v22, 7, v0
    v_lshlrev_b32 v22, 3, v22
    ds_read_b64 v[24:25], v22 offset:20992
    s_waitcnt lgkmcnt(0)
    v_add_f32 v20, v24, v25
    v_mul_f32 v20, 0x3b000000, v20
    v_sub_f32 v48, v48, v20
    v_sub_f32 v49, v49, v20
    v_sub_f32 v50, v50, v20
    v_sub_f32 v51, v51, v20
    v_mul_f32 v20, v48, v48
    v_fmac_f32 v20, v49, v49
    v_fmac_f32 v20, v50, v50
    v_fmac_f32 v20, v51, v51
    s_nop 1
    v_add_f32_dpp v20, v20, v20 row_ror:8 row_mask:0xf bank_mask:0xf
    s_nop 1
    v_add_f32_dpp v20, v20, v20 row_ror:4 row_mask:0xf bank_mask:0xf
    s_nop 1
    v_add_f32_dpp v20, v20, v20 row_ror:2 row_mask:0xf bank_mask:0xf
    s_nop 1
    v_add_f32_dpp v20, v20, v20 row_ror:1 row_mask:0xf bank_mask:0xf
    s_nop 1
    v_readlane_b32 s60, v20, 0
    v_readlane_b32 s61, v20, 16
    v_readlane_b32 s62, v20, 32
    v_readlane_b32 s63, v20, 48
    s_nop 1
    v_mov_b32 v20, s60
    v_add_f32 v20, s61, v20
    v_add_f32 v20, s62, v20
    v_add_f32 v20, s63, v20
    ds_write_b32 v21, v20 offset:21008
    s_waitcnt lgkmcnt(0)
    s_barrier
    ds_read_b64 v[24:25], v22 offset:21008
    s_waitcnt lgkmcnt(0)
    v_add_f32 v20, v24, v25
    v_mov_b32 v23, 0x3727c5ac
    v_fmac_f32 v23, 0x3b000000, v20
    v_rsq_f32 v23, v23
    s_nop 0
    v_mul_f32 v48, v48, v23
    v_cvt_pk_bf16_f32 v20, v48, v48
    v_lshlrev_b32 v48, 16, v20
    v_mul_f32 v49, v49, v23
    v_cvt_pk_bf16_f32 v20, v49, v49
    v_lshlrev_b32 v49, 16, v20
    v_mul_f32 v50, v50, v23
    v_cvt_pk_bf16_f32 v20, v50, v50
    v_lshlrev_b32 v50, 16, v20
    v_mul_f32 v51, v51, v23
    v_cvt_pk_bf16_f32 v20, v51, v51
    v_lshlrev_b32 v51, 16, v20
    v_lshlrev_b32 v1, 4, v0
    ds_write_b128 v1, v[48:51] offset:16384
    s_waitcnt lgkmcnt(0)
    s_barrier
    v_mov_b32 v64, 0
    v_mov_b32 v65, 0
    v_mov_b32 v66, 0
    v_mov_b32 v67, 0
    v_mov_b32 v68, 0
    v_mov_b32 v69, 0
    v_mov_b32 v70, 0
    v_mov_b32 v71, 0
    v_mov_b32 v72, 0
    v_mov_b32 v73, 0
    v_mov_b32 v74, 0
    v_mov_b32 v75, 0
    v_mov_b32 v76, 0
    v_mov_b32 v77, 0
    v_mov_b32 v78, 0
    v_mov_b32 v79, 0
    v_mov_b32 v80, 0
    v_mov_b32 v81, 0
    v_mov_b32 v82, 0
    v_mov_b32 v83, 0
    v_mov_b32 v84, 0
    v_mov_b32 v85, 0
    v_mov_b32 v86, 0
    v_mov_b32 v87, 0
    v_mov_b32 v88, 0
    v_mov_b32 v89, 0
    v_mov_b32 v90, 0
    v_mov_b32 v91, 0
    v_mov_b32 v92, 0
    v_mov_b32 v93, 0
    v_mov_b32 v94, 0
    v_mov_b32 v95, 0
    v_lshlrev_b32 v5, 2, v0
    ds_read_b32 v52, v5 offset:16384
    ds_read_b32 v53, v5 offset:18432
    ds_read_b32 v54, v5 offset:17408
    ds_read_b32 v55, v5 offset:19456
    s_waitcnt lgkmcnt(0)
    v_lshlrev_b32 v16, 16, v192
    v_and_b32 v17, 0xffff0000, v192
    v_lshlrev_b32 v18, 16, v193
    v_and_b32 v19, 0xffff0000, v193
    v_lshlrev_b32 v20, 16, v194
    v_and_b32 v21, 0xffff0000, v194
    v_lshlrev_b32 v22, 16, v195
    v_and_b32 v23, 0xffff0000, v195
    v_lshlrev_b32 v24, 16, v200
    v_and_b32 v25, 0xffff0000, v200
    v_lshlrev_b32 v26, 16, v201
    v_and_b32 v27, 0xffff0000, v201
    v_lshlrev_b32 v28, 16, v202
    v_and_b32 v29, 0xffff0000, v202
    v_lshlrev_b32 v30, 16, v203
    v_and_b32 v31, 0xffff0000, v203
    v_fmac_f32 v64, v52, v16
    v_fmac_f32 v72, v53, v16
    v_fmac_f32 v80, v52, v24
    v_fmac_f32 v88, v53, v24
    v_fmac_f32 v65, v52, v17
    v_fmac_f32 v73, v53, v17
    v_fmac_f32 v81, v52, v25
    v_fmac_f32 v89, v53, v25
    v_fmac_f32 v66, v52, v18
    v_fmac_f32 v74, v53, v18
    v_fmac_f32 v82, v52, v26
    v_fmac_f32 v90, v53, v26
    v_fmac_f32 v67, v52, v19
    v_fmac_f32 v75, v53, v19
    v_fmac_f32 v83, v52, v27
    v_fmac_f32 v91, v53, v27
    v_fmac_f32 v68, v52, v20
    v_fmac_f32 v76, v53, v20
    v_fmac_f32 v84, v52, v28
    v_fmac_f32 v92, v53, v28
    v_fmac_f32 v69, v52, v21
    v_fmac_f32 v77, v53, v21
    v_fmac_f32 v85, v52, v29
    v_fmac_f32 v93, v53, v29
    v_fmac_f32 v70, v52, v22
    v_fmac_f32 v78, v53, v22
    v_fmac_f32 v86, v52, v30
    v_fmac_f32 v94, v53, v30
    v_fmac_f32 v71, v52, v23
    v_fmac_f32 v79, v53, v23
    v_fmac_f32 v87, v52, v31
    v_fmac_f32 v95, v53, v31
    v_lshlrev_b32 v16, 16, v196
    v_and_b32 v17, 0xffff0000, v196
    v_lshlrev_b32 v18, 16, v197
    v_and_b32 v19, 0xffff0000, v197
    v_lshlrev_b32 v20, 16, v198
    v_and_b32 v21, 0xffff0000, v198
    v_lshlrev_b32 v22, 16, v199
    v_and_b32 v23, 0xffff0000, v199
    v_lshlrev_b32 v24, 16, v204
    v_and_b32 v25, 0xffff0000, v204
    v_lshlrev_b32 v26, 16, v205
    v_and_b32 v27, 0xffff0000, v205
    v_lshlrev_b32 v28, 16, v206
    v_and_b32 v29, 0xffff0000, v206
    v_lshlrev_b32 v30, 16, v207
    v_and_b32 v31, 0xffff0000, v207
    v_fmac_f32 v64, v54, v16
    v_fmac_f32 v72, v55, v16
    v_fmac_f32 v80, v54, v24
    v_fmac_f32 v88, v55, v24
    v_fmac_f32 v65, v54, v17
    v_fmac_f32 v73, v55, v17
    v_fmac_f32 v81, v54, v25
    v_fmac_f32 v89, v55, v25
    v_fmac_f32 v66, v54, v18
    v_fmac_f32 v74, v55, v18
    v_fmac_f32 v82, v54, v26
    v_fmac_f32 v90, v55, v26
    v_fmac_f32 v67, v54, v19
    v_fmac_f32 v75, v55, v19
    v_fmac_f32 v83, v54, v27
    v_fmac_f32 v91, v55, v27
    v_fmac_f32 v68, v54, v20
    v_fmac_f32 v76, v55, v20
    v_fmac_f32 v84, v54, v28
    v_fmac_f32 v92, v55, v28
    v_fmac_f32 v69, v54, v21
    v_fmac_f32 v77, v55, v21
    v_fmac_f32 v85, v54, v29
    v_fmac_f32 v93, v55, v29
    v_fmac_f32 v70, v54, v22
    v_fmac_f32 v78, v55, v22
    v_fmac_f32 v86, v54, v30
    v_fmac_f32 v94, v55, v30
    v_fmac_f32 v71, v54, v23
    v_fmac_f32 v79, v55, v23
    v_fmac_f32 v87, v54, v31
    v_fmac_f32 v95, v55, v31
    v_lshlrev_b32 v1, 7, v0
    ds_write_b128 v1, v[64:67] offset:28672
    ds_write_b128 v1, v[68:71] offset:28688
    ds_write_b128 v1, v[72:75] offset:28704
    ds_write_b128 v1, v[76:79] offset:28720
    ds_write_b128 v1, v[80:83] offset:28736
    ds_write_b128 v1, v[84:87] offset:28752
    ds_write_b128 v1, v[88:91] offset:28768
    ds_write_b128 v1, v[92:95] offset:28784
    s_waitcnt lgkmcnt(0)
    s_barrier
    v_and_b32 v1, 31, v0
    v_lshlrev_b32 v1, 2, v1
    v_lshrrev_b32 v2, 5, v0
    v_lshl_add_u32 v1, v2, 12, v1
    ds_read_b32 v16, v1 offset:28672
    ds_read_b32 v17, v1 offset:28800
    ds_read_b32 v18, v1 offset:28928
    ds_read_b32 v19, v1 offset:29056
    ds_read_b32 v20, v1 offset:29184
    ds_read_b32 v21, v1 offset:29312
    ds_read_b32 v22, v1 offset:29440
    ds_read_b32 v23, v1 offset:29568
    ds_read_b32 v24, v1 offset:29696
    ds_read_b32 v25, v1 offset:29824
    ds_read_b32 v26, v1 offset:29952
    ds_read_b32 v27, v1 offset:30080
    ds_read_b32 v28, v1 offset:30208
    ds_read_b32 v29, v1 offset:30336
    ds_read_b32 v30, v1 offset:30464
    ds_read_b32 v31, v1 offset:30592
    ds_read_b32 v32, v1 offset:30720
    ds_read_b32 v33, v1 offset:30848
    ds_read_b32 v34, v1 offset:30976
    ds_read_b32 v35, v1 offset:31104
    ds_read_b32 v36, v1 offset:31232
    ds_read_b32 v37, v1 offset:31360
    ds_read_b32 v38, v1 offset:31488
    ds_read_b32 v39, v1 offset:31616
    ds_read_b32 v40, v1 offset:31744
    ds_read_b32 v41, v1 offset:31872
    ds_read_b32 v42, v1 offset:32000
    ds_read_b32 v43, v1 offset:32128
    ds_read_b32 v44, v1 offset:32256
    ds_read_b32 v45, v1 offset:32384
    ds_read_b32 v46, v1 offset:32512
    ds_read_b32 v47, v1 offset:32640
    s_waitcnt lgkmcnt(0)
    v_add_f32 v16, v16, v17
    v_add_f32 v16, v16, v18
    v_add_f32 v16, v16, v19
    v_add_f32 v16, v16, v20
    v_add_f32 v16, v16, v21
    v_add_f32 v16, v16, v22
    v_add_f32 v16, v16, v23
    v_add_f32 v16, v16, v24
    v_add_f32 v16, v16, v25
    v_add_f32 v16, v16, v26
    v_add_f32 v16, v16, v27
    v_add_f32 v16, v16, v28
    v_add_f32 v16, v16, v29
    v_add_f32 v16, v16, v30
    v_add_f32 v16, v16, v31
    v_add_f32 v16, v16, v32
    v_add_f32 v16, v16, v33
    v_add_f32 v16, v16, v34
    v_add_f32 v16, v16, v35
    v_add_f32 v16, v16, v36
    v_add_f32 v16, v16, v37
    v_add_f32 v16, v16, v38
    v_add_f32 v16, v16, v39
    v_add_f32 v16, v16, v40
    v_add_f32 v16, v16, v41
    v_add_f32 v16, v16, v42
    v_add_f32 v16, v16, v43
    v_add_f32 v16, v16, v44
    v_add_f32 v16, v16, v45
    v_add_f32 v16, v16, v46
    v_add_f32 v16, v16, v47
    v_lshlrev_b32 v1, 2, v0
    ds_write_b32 v1, v16 offset:20736
    s_waitcnt lgkmcnt(0)
    s_barrier
    v_cmp_gt_u32 vcc, 8, v0
    s_and_saveexec_b64 s[82:83], vcc
    v_lshlrev_b32 v1, 2, v0
    ds_read_b32 v16, v1 offset:20736
    ds_read_b32 v17, v1 offset:20768
    ds_read_b32 v18, v1 offset:20800
    ds_read_b32 v19, v1 offset:20832
    ds_read_b32 v20, v1 offset:20864
    ds_read_b32 v21, v1 offset:20896
    ds_read_b32 v22, v1 offset:20928
    ds_read_b32 v23, v1 offset:20960
    ds_read_b32 v24, v1 offset:20992
    ds_read_b32 v25, v1 offset:21024
    ds_read_b32 v26, v1 offset:21056
    ds_read_b32 v27, v1 offset:21088
    ds_read_b32 v28, v1 offset:21120
    ds_read_b32 v29, v1 offset:21152
    ds_read_b32 v30, v1 offset:21184
    ds_read_b32 v31, v1 offset:21216
    ds_read_b32 v32, v1 offset:21248
    ds_read_b32 v33, v1 offset:21280
    ds_read_b32 v34, v1 offset:21312
    ds_read_b32 v35, v1 offset:21344
    ds_read_b32 v36, v1 offset:21376
    ds_read_b32 v37, v1 offset:21408
    ds_read_b32 v38, v1 offset:21440
    ds_read_b32 v39, v1 offset:21472
    ds_read_b32 v40, v1 offset:21504
    ds_read_b32 v41, v1 offset:21536
    ds_read_b32 v42, v1 offset:21568
    ds_read_b32 v43, v1 offset:21600
    ds_read_b32 v44, v1 offset:21632
    ds_read_b32 v45, v1 offset:21664
    ds_read_b32 v46, v1 offset:21696
    ds_read_b32 v47, v1 offset:21728
    s_waitcnt lgkmcnt(0)
    v_add_f32 v16, v16, v20
    v_add_f32 v17, v17, v21
    v_add_f32 v18, v18, v22
    v_add_f32 v19, v19, v23
    v_add_f32 v16, v16, v24
    v_add_f32 v17, v17, v25
    v_add_f32 v18, v18, v26
    v_add_f32 v19, v19, v27
    v_add_f32 v16, v16, v28
    v_add_f32 v17, v17, v29
    v_add_f32 v18, v18, v30
    v_add_f32 v19, v19, v31
    v_add_f32 v16, v16, v32
    v_add_f32 v17, v17, v33
    v_add_f32 v18, v18, v34
    v_add_f32 v19, v19, v35
    v_add_f32 v16, v16, v36
    v_add_f32 v17, v17, v37
    v_add_f32 v18, v18, v38
    v_add_f32 v19, v19, v39
    v_add_f32 v16, v16, v40
    v_add_f32 v17, v17, v41
    v_add_f32 v18, v18, v42
    v_add_f32 v19, v19, v43
    v_add_f32 v16, v16, v44
    v_add_f32 v17, v17, v45
    v_add_f32 v18, v18, v46
    v_add_f32 v19, v19, v47
    v_cvt_pk_bf16_f32 v20, v16, v16
    v_lshlrev_b32 v16, 16, v20
    v_cvt_pk_bf16_f32 v20, v17, v17
    v_lshlrev_b32 v17, 16, v20
    v_cvt_pk_bf16_f32 v20, v18, v18
    v_lshlrev_b32 v18, 16, v20
    v_cvt_pk_bf16_f32 v20, v19, v19
    v_lshlrev_b32 v19, 16, v20
    v_mul_f32 v20, 0xbfb8aa3b, v16
    v_exp_f32 v20, v20
    s_nop 0
    v_add_f32 v20, 1.0, v20
    v_rcp_f32 v20, v20
    s_nop 0
    v_cvt_pk_bf16_f32 v22, v20, v20
    v_lshlrev_b32 v20, 16, v22
    v_mul_f32 v20, v20, v18
    v_mul_f32 v21, 0xbfb8aa3b, v17
    v_exp_f32 v21, v21
    s_nop 0
    v_add_f32 v21, 1.0, v21
    v_rcp_f32 v21, v21
    s_nop 0
    v_cvt_pk_bf16_f32 v22, v21, v21
    v_lshlrev_b32 v21, 16, v22
    v_mul_f32 v21, v21, v19
    v_cvt_pk_bf16_f32 v2, v20, v21
    v_mov_b32 v3, s80
    v_lshlrev_b32 v1, 3, v0
    s_lshl_b32 s52, s6, 6
    s_add_u32 s52, s52, 1507328
    buffer_store_dwordx2 v[2:3], v1, s[44:47], s52 offen sc0 sc1
    s_mov_b64 exec, s[82:83]
L_skipD:
    s_cmp_lt_u32 s2, 192
    s_cbranch_scc1 L_done
    v_lshlrev_b32 v2, 3, v0
    s_mov_b32 s52, 1507328
    s_mov_b32 s53, 1511424
    s_mov_b32 s94, 1515520
    s_mov_b32 s95, 1519616
    s_mov_b32 s81, 100000
Lpoll5:
    buffer_load_dwordx2 v[48:49], v2, s[44:47], s52 offen offset:0 sc0 sc1
    buffer_load_dwordx2 v[50:51], v2, s[44:47], s52 offen offset:2048 sc0 sc1
    buffer_load_dwordx2 v[52:53], v2, s[44:47], s53 offen offset:0 sc0 sc1
    buffer_load_dwordx2 v[54:55], v2, s[44:47], s53 offen offset:2048 sc0 sc1
    buffer_load_dwordx2 v[56:57], v2, s[44:47], s94 offen offset:0 sc0 sc1
    buffer_load_dwordx2 v[58:59], v2, s[44:47], s94 offen offset:2048 sc0 sc1
    buffer_load_dwordx2 v[60:61], v2, s[44:47], s95 offen offset:0 sc0 sc1
    s_waitcnt vmcnt(0)
    v_cmp_ne_u32 vcc, s80, v49
    v_cmp_ne_u32 s[82:83], s80, v51
    s_or_b64 vcc, vcc, s[82:83]
    v_cmp_ne_u32 s[82:83], s80, v53
    s_or_b64 vcc, vcc, s[82:83]
    v_cmp_ne_u32 s[82:83], s80, v55
    s_or_b64 vcc, vcc, s[82:83]
    v_cmp_ne_u32 s[82:83], s80, v57
    s_or_b64 vcc, vcc, s[82:83]
    v_cmp_ne_u32 s[82:83], s80, v59
    s_or_b64 vcc, vcc, s[82:83]
    v_cmp_ne_u32 s[82:83], s80, v61
    s_or_b64 vcc, vcc, s[82:83]
    s_cbranch_vccz Lpoll5_ok
    s_sleep 1
    s_sub_u32 s81, s81, 1
    s_cmp_eq_u32 s81, 0
    s_cbranch_scc0 Lpoll5
Lpoll5_ok:
    v_mov_b32 v236, 0
    v_mov_b32 v237, 0
    v_mov_b32 v238, 0
    v_mov_b32 v239, 0
    v_mov_b32 v240, 0
    v_mov_b32 v241, 0
    v_mov_b32 v242, 0
    v_mov_b32 v243, 0
    v_mov_b32 v244, 0
    v_mov_b32 v245, 0
    v_mov_b32 v246, 0
    v_mov_b32 v247, 0
    v_mov_b32 v248, 0
    v_mov_b32 v249, 0
    v_mov_b32 v250, 0
    v_mov_b32 v251, 0
    v_lshlrev_b32 v24, 16, v48
    v_and_b32 v25, 0xffff0000, v48
    v_lshlrev_b32 v16, 16, v208
    v_and_b32 v17, 0xffff0000, v208
    v_lshlrev_b32 v18, 16, v209
    v_and_b32 v19, 0xffff0000, v209
    v_lshlrev_b32 v20, 16, v210
    v_and_b32 v21, 0xffff0000, v210
    v_lshlrev_b32 v22, 16, v211
    v_and_b32 v23, 0xffff0000, v211
    v_fmac_f32 v236, v24, v16
    v_fmac_f32 v244, v25, v16
    v_fmac_f32 v237, v24, v17
    v_fmac_f32 v245, v25, v17
    v_fmac_f32 v238, v24, v18
    v_fmac_f32 v246, v25, v18
    v_fmac_f32 v239, v24, v19
    v_fmac_f32 v247, v25, v19
    v_fmac_f32 v240, v24, v20
    v_fmac_f32 v248, v25, v20
    v_fmac_f32 v241, v24, v21
    v_fmac_f32 v249, v25, v21
    v_fmac_f32 v242, v24, v22
    v_fmac_f32 v250, v25, v22
    v_fmac_f32 v243, v24, v23
    v_fmac_f32 v251, v25, v23
    v_lshlrev_b32 v24, 16, v50
    v_and_b32 v25, 0xffff0000, v50
    v_lshlrev_b32 v16, 16, v212
    v_and_b32 v17, 0xffff0000, v212
    v_lshlrev_b32 v18, 16, v213
    v_and_b32 v19, 0xffff0000, v213
    v_lshlrev_b32 v20, 16, v214
    v_and_b32 v21, 0xffff0000, v214
    v_lshlrev_b32 v22, 16, v215
    v_and_b32 v23, 0xffff0000, v215
    v_fmac_f32 v236, v24, v16
    v_fmac_f32 v244, v25, v16
    v_fmac_f32 v237, v24, v17
    v_fmac_f32 v245, v25, v17
    v_fmac_f32 v238, v24, v18
    v_fmac_f32 v246, v25, v18
    v_fmac_f32 v239, v24, v19
    v_fmac_f32 v247, v25, v19
    v_fmac_f32 v240, v24, v20
    v_fmac_f32 v248, v25, v20
    v_fmac_f32 v241, v24, v21
    v_fmac_f32 v249, v25, v21
    v_fmac_f32 v242, v24, v22
    v_fmac_f32 v250, v25, v22
    v_fmac_f32 v243, v24, v23
    v_fmac_f32 v251, v25, v23
    v_lshlrev_b32 v24, 16, v52
    v_and_b32 v25, 0xffff0000, v52
    v_lshlrev_b32 v16, 16, v216
    v_and_b32 v17, 0xffff0000, v216
    v_lshlrev_b32 v18, 16, v217
    v_and_b32 v19, 0xffff0000, v217
    v_lshlrev_b32 v20, 16, v218
    v_and_b32 v21, 0xffff0000, v218
    v_lshlrev_b32 v22, 16, v219
    v_and_b32 v23, 0xffff0000, v219
    v_fmac_f32 v236, v24, v16
    v_fmac_f32 v244, v25, v16
    v_fmac_f32 v237, v24, v17
    v_fmac_f32 v245, v25, v17
    v_fmac_f32 v238, v24, v18
    v_fmac_f32 v246, v25, v18
    v_fmac_f32 v239, v24, v19
    v_fmac_f32 v247, v25, v19
    v_fmac_f32 v240, v24, v20
    v_fmac_f32 v248, v25, v20
    v_fmac_f32 v241, v24, v21
    v_fmac_f32 v249, v25, v21
    v_fmac_f32 v242, v24, v22
    v_fmac_f32 v250, v25, v22
    v_fmac_f32 v243, v24, v23
    v_fmac_f32 v251, v25, v23
    v_lshlrev_b32 v24, 16, v54
    v_and_b32 v25, 0xffff0000, v54
    v_lshlrev_b32 v16, 16, v220
    v_and_b32 v17, 0xffff0000, v220
    v_lshlrev_b32 v18, 16, v221
    v_and_b32 v19, 0xffff0000, v221
    v_lshlrev_b32 v20, 16, v222
    v_and_b32 v21, 0xffff0000, v222
    v_lshlrev_b32 v22, 16, v223
    v_and_b32 v23, 0xffff0000, v223
    v_fmac_f32 v236, v24, v16
    v_fmac_f32 v244, v25, v16
    v_fmac_f32 v237, v24, v17
    v_fmac_f32 v245, v25, v17
    v_fmac_f32 v238, v24, v18
    v_fmac_f32 v246, v25, v18
    v_fmac_f32 v239, v24, v19
    v_fmac_f32 v247, v25, v19
    v_fmac_f32 v240, v24, v20
    v_fmac_f32 v248, v25, v20
    v_fmac_f32 v241, v24, v21
    v_fmac_f32 v249, v25, v21
    v_fmac_f32 v242, v24, v22
    v_fmac_f32 v250, v25, v22
    v_fmac_f32 v243, v24, v23
    v_fmac_f32 v251, v25, v23
    v_lshlrev_b32 v24, 16, v56
    v_and_b32 v25, 0xffff0000, v56
    v_lshlrev_b32 v16, 16, v224
    v_and_b32 v17, 0xffff0000, v224
    v_lshlrev_b32 v18, 16, v225
    v_and_b32 v19, 0xffff0000, v225
    v_lshlrev_b32 v20, 16, v226
    v_and_b32 v21, 0xffff0000, v226
    v_lshlrev_b32 v22, 16, v227
    v_and_b32 v23, 0xffff0000, v227
    v_fmac_f32 v236, v24, v16
    v_fmac_f32 v244, v25, v16
    v_fmac_f32 v237, v24, v17
    v_fmac_f32 v245, v25, v17
    v_fmac_f32 v238, v24, v18
    v_fmac_f32 v246, v25, v18
    v_fmac_f32 v239, v24, v19
    v_fmac_f32 v247, v25, v19
    v_fmac_f32 v240, v24, v20
    v_fmac_f32 v248, v25, v20
    v_fmac_f32 v241, v24, v21
    v_fmac_f32 v249, v25, v21
    v_fmac_f32 v242, v24, v22
    v_fmac_f32 v250, v25, v22
    v_fmac_f32 v243, v24, v23
    v_fmac_f32 v251, v25, v23
    v_lshlrev_b32 v24, 16, v58
    v_and_b32 v25, 0xffff0000, v58
    v_lshlrev_b32 v16, 16, v228
    v_and_b32 v17, 0xffff0000, v228
    v_lshlrev_b32 v18, 16, v229
    v_and_b32 v19, 0xffff0000, v229
    v_lshlrev_b32 v20, 16, v230
    v_and_b32 v21, 0xffff0000, v230
    v_lshlrev_b32 v22, 16, v231
    v_and_b32 v23, 0xffff0000, v231
    v_fmac_f32 v236, v24, v16
    v_fmac_f32 v244, v25, v16
    v_fmac_f32 v237, v24, v17
    v_fmac_f32 v245, v25, v17
    v_fmac_f32 v238, v24, v18
    v_fmac_f32 v246, v25, v18
    v_fmac_f32 v239, v24, v19
    v_fmac_f32 v247, v25, v19
    v_fmac_f32 v240, v24, v20
    v_fmac_f32 v248, v25, v20
    v_fmac_f32 v241, v24, v21
    v_fmac_f32 v249, v25, v21
    v_fmac_f32 v242, v24, v22
    v_fmac_f32 v250, v25, v22
    v_fmac_f32 v243, v24, v23
    v_fmac_f32 v251, v25, v23
    v_lshlrev_b32 v24, 16, v60
    v_and_b32 v25, 0xffff0000, v60
    v_lshlrev_b32 v16, 16, v232
    v_and_b32 v17, 0xffff0000, v232
    v_lshlrev_b32 v18, 16, v233
    v_and_b32 v19, 0xffff0000, v233
    v_lshlrev_b32 v20, 16, v234
    v_and_b32 v21, 0xffff0000, v234
    v_lshlrev_b32 v22, 16, v235
    v_and_b32 v23, 0xffff0000, v235
    v_fmac_f32 v236, v24, v16
    v_fmac_f32 v244, v25, v16
    v_fmac_f32 v237, v24, v17
    v_fmac_f32 v245, v25, v17
    v_fmac_f32 v238, v24, v18
    v_fmac_f32 v246, v25, v18
    v_fmac_f32 v239, v24, v19
    v_fmac_f32 v247, v25, v19
    v_fmac_f32 v240, v24, v20
    v_fmac_f32 v248, v25, v20
    v_fmac_f32 v241, v24, v21
    v_fmac_f32 v249, v25, v21
    v_fmac_f32 v242, v24, v22
    v_fmac_f32 v250, v25, v22
    v_fmac_f32 v243, v24, v23
    v_fmac_f32 v251, v25, v23
    s_barrier
    v_lshlrev_b32 v1, 6, v0
    ds_write_b128 v1, v[236:239] offset:0
    ds_write_b128 v1, v[240:243] offset:16
    ds_write_b128 v1, v[244:247] offset:32
    ds_write_b128 v1, v[248:251] offset:48
    s_waitcnt lgkmcnt(0)
    s_barrier
    v_lshrrev_b32 v2, 4, v0
    v_lshlrev_b32 v2, 10, v2
    v_and_b32 v3, 15, v0
    v_lshl_add_u32 v2, v3, 2, v2
    ds_read_b32 v16, v2 offset:0
    ds_read_b32 v17, v2 offset:64
    ds_read_b32 v18, v2 offset:128
    ds_read_b32 v19, v2 offset:192
    ds_read_b32 v20, v2 offset:256
    ds_read_b32 v21, v2 offset:320
    ds_read_b32 v22, v2 offset:384
    ds_read_b32 v23, v2 offset:448
    ds_read_b32 v24, v2 offset:512
    ds_read_b32 v25, v2 offset:576
    ds_read_b32 v26, v2 offset:640
    ds_read_b32 v27, v2 offset:704
    ds_read_b32 v28, v2 offset:768
    ds_read_b32 v29, v2 offset:832
    ds_read_b32 v30, v2 offset:896
    ds_read_b32 v31, v2 offset:960
    s_waitcnt lgkmcnt(0)
    v_add_f32 v16, v16, v17
    v_add_f32 v16, v16, v18
    v_add_f32 v16, v16, v19
    v_add_f32 v16, v16, v20
    v_add_f32 v16, v16, v21
    v_add_f32 v16, v16, v22
    v_add_f32 v16, v16, v23
    v_add_f32 v16, v16, v24
    v_add_f32 v16, v16, v25
    v_add_f32 v16, v16, v26
    v_add_f32 v16, v16, v27
    v_add_f32 v16, v16, v28
    v_add_f32 v16, v16, v29
    v_add_f32 v16, v16, v30
    v_add_f32 v16, v16, v31
    v_lshlrev_b32 v1, 2, v0
    ds_write_b32 v1, v16 offset:20736
    s_waitcnt lgkmcnt(0)
    s_barrier
    v_cmp_gt_u32 vcc, 16, v0
    s_and_saveexec_b64 s[82:83], vcc
    ds_read_b32 v16, v1 offset:20736
    ds_read_b32 v17, v1 offset:20800
    ds_read_b32 v18, v1 offset:20864
    ds_read_b32 v19, v1 offset:20928
    ds_read_b32 v20, v1 offset:20992
    ds_read_b32 v21, v1 offset:21056
    ds_read_b32 v22, v1 offset:21120
    ds_read_b32 v23, v1 offset:21184
    ds_read_b32 v24, v1 offset:21248
    ds_read_b32 v25, v1 offset:21312
    ds_read_b32 v26, v1 offset:21376
    ds_read_b32 v27, v1 offset:21440
    ds_read_b32 v28, v1 offset:21504
    ds_read_b32 v29, v1 offset:21568
    ds_read_b32 v30, v1 offset:21632
    ds_read_b32 v31, v1 offset:21696
    v_lshrrev_b32 v4, 3, v0
    v_and_b32 v3, 7, v0
    v_lshl_add_u32 v5, v4, 9, v3
    s_mov_b32 s52, s7
    s_lshl_b32 s52, s52, 3
    v_add_u32 v5, s52, v5
    v_lshlrev_b32 v6, 2, v5
    ds_read_b32 v7, v6 offset:24576
    s_waitcnt lgkmcnt(0)
    v_add_f32 v16, v16, v17
    v_add_f32 v16, v16, v18
    v_add_f32 v16, v16, v19
    v_add_f32 v16, v16, v20
    v_add_f32 v16, v16, v21
    v_add_f32 v16, v16, v22
    v_add_f32 v16, v16, v23
    v_add_f32 v16, v16, v24
    v_add_f32 v16, v16, v25
    v_add_f32 v16, v16, v26
    v_add_f32 v16, v16, v27
    v_add_f32 v16, v16, v28
    v_add_f32 v16, v16, v29
    v_add_f32 v16, v16, v30
    v_add_f32 v16, v16, v31
    v_cvt_pk_bf16_f32 v8, v16, v16
    v_lshlrev_b32 v16, 16, v8
    v_add_f32 v16, v16, v7
    v_cvt_pk_bf16_f32 v16, v16, v16
    v_lshlrev_b32 v6, 1, v5
    buffer_store_short v16, v6, s[40:43], 0 offen
L_done:
    s_endpgm
.section .rodata,"a"
.p2align 6
.amdhsa_kernel sequential_preLN__sliding_block_cached__glu_gated_glu__decode_kernel
  .amdhsa_next_free_vgpr 256
  .amdhsa_next_free_sgpr 102
  .amdhsa_accum_offset 256
  .amdhsa_group_segment_fixed_size 0
  .amdhsa_kernarg_size 96
  .amdhsa_user_sgpr_count 2
  .amdhsa_user_sgpr_kernarg_segment_ptr 1
  .amdhsa_system_sgpr_workgroup_id_x 1
.end_amdhsa_kernel
```
